```python
import torch

def _softmax(x, axis=-1):
    return torch.softmax(x, dim=axis)

def _gelu(x):
    return torch.nn.functional.gelu(x, approximate='tanh')

def _silu(x):
    return torch.nn.functional.silu(x)

def _sigmoid(x):
    return torch.sigmoid(x)

def _layernorm(x, axis=-1, eps=1e-05):
    m = x.mean(dim=axis, keepdim=True)
    v = x.var(dim=axis, keepdim=True, unbiased=False)
    return (x - m) / torch.sqrt(v + eps)

def _scatter_add(tgt, idx, src, axis=0):
    return tgt.clone().index_add_(axis, idx, src)

def _segment_sum(src, seg, n):
    out = torch.zeros((n,) + src.shape[1:], dtype=src.dtype)
    return out.index_add_(0, seg, src)

def _pad(x, pw):
    flat = tuple((v for pair in reversed(pw) for v in pair))
    return torch.nn.functional.pad(x, flat)
kernel_name = 'standalone__autoregressive_conv_wavenet__speech'

def setup_inputs():

    _w = lambda a: (lambda t: t.to(torch.bfloat16) if t.is_floating_point() else t)(torch.as_tensor(a))
    B, T, D, K = (2, 4000, 144, 15)
    return {'x': _w((lambda *s: torch.randn(*s, dtype=torch.bfloat16) * 0.1)(B, T, D)), 'w': _w((lambda *s: torch.randn(*s, dtype=torch.bfloat16) * 0.1)(K, D, 2 * D)), 'w_o': _w((lambda *s: torch.randn(*s, dtype=torch.bfloat16) * 0.05)(D, D))}

def reference(x, w, w_o):
    B, T, D = x.shape
    K = w.shape[0]
    dil = 2
    pad = (K - 1) * dil
    xp = _pad(x, ((0, 0), (pad, 0), (0, 0)))
    h = torch.einsum('btc,cd->btd', xp[:, pad:pad + T, :], w[0])
    for i in range(1, K):
        off = pad - i * dil
        h = h + torch.einsum('btc,cd->btd', xp[:, off:off + T, :], w[i])
    f = h[..., :D].clone()
    g = h[..., D:].clone()
    z = torch.tanh(f) * _sigmoid(g)
    return z @ w_o
```

```asm
; @launch grid=(256,1,1) block=(512,1,1) lds=157696
.amdgcn_target "amdgcn-amd-amdhsa--gfx950"
.text
.globl standalone__autoregressive_conv_wavenet__speech_kernel
.p2align 12
.p2align 8
.type standalone__autoregressive_conv_wavenet__speech_kernel,@function
standalone__autoregressive_conv_wavenet__speech_kernel:
    s_load_dwordx8 s[4:11], s[0:1], 0
    s_load_dwordx4 s[24:27], s[0:1], 32
    s_cmp_ge_u32 s2, 256
    s_cbranch_scc1 L_end
    s_and_b32 s42, s2, 7
    s_lshr_b32 s79, s2, 3
    s_mul_i32 s44, s42, 27
    s_add_u32 s44, s44, s79
    s_sub_u32 s36, s79, 27
    s_and_b32 s37, s42, 1
    s_mul_i32 s45, s37, 5
    s_add_u32 s45, s45, s36
    s_cmp_ge_u32 s79, 27
    s_cselect_b32 s46, s45, 0
    s_cmp_ge_u32 s46, 9
    s_cbranch_scc1 L_end
    s_lshr_b32 s46, s42, 1
    s_mul_i32 s46, s46, 9
    s_add_u32 s45, s45, s46
    s_add_u32 s45, s45, 216
    s_cmp_ge_u32 s79, 27
    s_cselect_b32 s44, s45, s44
    s_mul_hi_u32 s40, s44, 0x1c71c71d
    s_mul_i32 s45, s40, 9
    s_sub_u32 s41, s44, s45
    v_lshrrev_b32 v1, 6, v0
    v_and_b32 v2, 63, v0
    s_cmp_ge_u32 s40, 14
    v_readfirstlane_b32 s3, v1
    s_cselect_b32 s42, 1, 0
    s_mul_i32 s43, s42, 14
    s_sub_u32 s43, s40, s43
    s_mul_i32 s39, s42, 1152000
    s_mul_i32 s45, s43, 82944
    s_sub_u32 s45, s45, 8064
    s_mul_i32 s38, s44, 18432
    s_cmp_eq_u32 s3, 4
    s_cbranch_scc1 L_loader
    s_cmp_ge_u32 s3, 6
    s_cbranch_scc1 L_extra
    s_cmp_eq_u32 s3, 5
    s_cselect_b32 s46, 8, s3
    s_mov_b32 s47, 238609295
    s_cmp_eq_u32 s3, 5
    s_cbranch_scc1 L_nox
    s_add_u32 s48, s46, 0
    s_lshl_b32 s48, s48, 6
    v_add_u32 v3, s48, v2
    v_mul_hi_u32 v4, s47, v3
    v_mul_u32_u24 v5, 18, v4
    v_sub_u32 v5, v3, v5
    v_lshrrev_b32 v4, 2, v4
    v_and_b32 v4, 2, v4
    v_xor_b32 v4, v4, v5
    v_cmp_gt_u32 vcc, 16, v5
    v_sub_u32 v3, v3, v5
    s_nop 0
    v_cndmask_b32 v4, v5, v4, vcc
    v_add_u32 v3, v3, v4
    v_lshl_add_u32 v8, v3, 4, s45
    s_add_u32 s48, s46, 4
    s_lshl_b32 s48, s48, 6
    v_add_u32 v3, s48, v2
    v_mul_hi_u32 v4, s47, v3
    v_mul_u32_u24 v5, 18, v4
    v_sub_u32 v5, v3, v5
    v_lshrrev_b32 v4, 2, v4
    v_and_b32 v4, 2, v4
    v_xor_b32 v4, v4, v5
    v_cmp_gt_u32 vcc, 16, v5
    v_sub_u32 v3, v3, v5
    s_nop 0
    v_cndmask_b32 v4, v5, v4, vcc
    v_add_u32 v3, v3, v4
    v_lshl_add_u32 v9, v3, 4, s45
    s_mov_b32 s48, 8
    s_lshl_b32 s48, s48, 6
    v_add_u32 v3, s48, v2
    v_mul_hi_u32 v4, s47, v3
    v_mul_u32_u24 v5, 18, v4
    v_sub_u32 v5, v3, v5
    v_lshrrev_b32 v4, 2, v4
    v_and_b32 v4, 2, v4
    v_xor_b32 v4, v4, v5
    v_cmp_gt_u32 vcc, 16, v5
    v_sub_u32 v3, v3, v5
    s_nop 0
    v_cndmask_b32 v4, v5, v4, vcc
    v_add_u32 v3, v3, v4
    v_lshl_add_u32 v12, v3, 4, s45
    s_lshl_b32 s46, s46, 10
    s_add_u32 s46, s46, 65536
    s_lshl_b32 s48, s36, 1
    s_cmp_ge_u32 s40, 24
    s_cselect_b32 s48, s48, s41
    s_mul_i32 s48, s48, 9216
    s_mov_b32 s49, 9
L_nox:
    s_waitcnt lgkmcnt(0)
    s_add_u32 s12, s4, s39
    s_addc_u32 s13, s5, 0
    s_and_b32 s13, s13, 0xffff
    s_mov_b32 s14, 1152000
    s_mov_b32 s15, 0x20000
    s_cmp_eq_u32 s3, 5
    s_cbranch_scc1 L_helper
    s_add_u32 m0, s46, s48
    v_add_u32 v10, s48, v8
    buffer_load_dwordx4 v10, s[12:15], 0 offen nt lds
    s_add_u32 m0, m0, 4096
    v_add_u32 v11, s48, v9
    buffer_load_dwordx4 v11, s[12:15], 0 offen nt lds
    s_cmp_eq_u32 s3, 3
    s_cbranch_scc0 L_x8a
    s_add_u32 m0, s48, 73728
    v_add_u32 v13, s48, v12
    buffer_load_dwordx4 v13, s[12:15], 0 offen nt lds
L_x8a:
L_xa:
    s_add_u32 s48, s48, 9216
    s_cmp_ge_u32 s48, 92160
    s_cselect_b32 s48, 0, s48
    s_add_u32 m0, s46, s48
    v_add_u32 v10, s48, v8
    buffer_load_dwordx4 v10, s[12:15], 0 offen  lds
    s_add_u32 m0, m0, 4096
    v_add_u32 v11, s48, v9
    buffer_load_dwordx4 v11, s[12:15], 0 offen  lds
    s_and_b32 s47, s49, 3
    s_cmp_eq_u32 s47, s3
    s_cbranch_scc0 L_x8b
    s_add_u32 m0, s48, 73728
    v_add_u32 v13, s48, v12
    buffer_load_dwordx4 v13, s[12:15], 0 offen  lds
L_x8b:
    s_sub_u32 s49, s49, 1
    s_cmp_lg_u32 s49, 0
    s_cbranch_scc1 L_xa
    s_branch L_compute
L_loader:
    s_getpc_b64 s[60:61]
L_pc:
    s_sub_u32 s60, s60, L_pc-standalone__autoregressive_conv_wavenet__speech_kernel
    s_subb_u32 s61, s61, 0
    s_mul_i32 s62, s79, (L_textend-standalone__autoregressive_conv_wavenet__speech_kernel+4095)/4096
    v_add_u32 v5, s62, v2
    v_lshlrev_b32 v5, 7, v5
    v_min_u32 v5, L_textend-standalone__autoregressive_conv_wavenet__speech_kernel-128, v5
    s_mov_b32 exec_lo, (1<<((L_textend-standalone__autoregressive_conv_wavenet__speech_kernel+4095)/4096))-1
    s_mov_b32 exec_hi, 0
    global_load_dword v7, v5, s[60:61]
    s_mov_b64 exec, -1
    s_mul_i32 s47, s79, 36
    s_add_u32 s47, s47, 0
    v_add_u32 v12, s47, v2
    s_mov_b32 s47, 29826162
    v_mul_hi_u32 v18, s47, v12
    v_mul_u32_u24 v18, 64512, v18
    v_lshl_add_u32 v12, v12, 7, v18
    v_lshrrev_b32 v3, 2, v2
    v_mul_u32_u24 v3, 576, v3
    v_lshrrev_b32 v4, 5, v2
    v_lshlrev_b32 v4, 1, v4
    v_and_b32 v5, 3, v2
    v_xor_b32 v4, v4, v5
    v_lshl_add_u32 v3, v4, 4, v3
    v_lshlrev_b32 v4, 7, v2
    s_lshl_b32 s46, s41, 6
    s_mul_i32 s48, s79, 1408
    s_add_u32 s49, s45, 8064
    s_waitcnt lgkmcnt(0)
    s_mov_b32 s16, s6
    s_and_b32 s17, s7, 0xffff
    s_mov_b32 s18, 1244160
    s_mov_b32 s19, 0x20000
    s_mov_b32 exec_lo, 4294967295
    s_mov_b32 exec_hi, 15
    s_mov_b32 s47, 0
    buffer_load_dword v16, v12, s[16:19], s47 offen
    s_mov_b64 exec, -1
    s_branch L_loader2
L_helper:
    s_mov_b32 s20, s26
    s_and_b32 s21, s27, 0xffff
    s_mov_b32 s22, 4648448
    s_mov_b32 s23, 0x20000
    s_cmp_eq_u32 s41, 0
    s_cbranch_scc0 L_nolead
    s_lshl_b32 s47, s40, 7
    s_add_u32 s47, s47, 4644864
    v_mov_b32 v5, 0
    s_mov_b64 exec, 1
    buffer_store_dword v5, v5, s[20:23], s47 offen sc1
    s_mov_b64 exec, -1
L_nolead:
    s_mov_b32 s16, s6
    s_and_b32 s17, s7, 0xffff
    s_mov_b32 s18, 1244160
    s_mov_b32 s19, 0x20000
    s_mov_b32 s32, s8
    s_and_b32 s33, s9, 0xffff
    s_mov_b32 s34, 41472
    s_mov_b32 s35, 0x20000
    s_mul_i32 s47, s79, 68
    s_add_u32 s47, s47, 0
    v_add_u32 v13, s47, v2
    s_mov_b32 s47, 29826162
    v_mul_hi_u32 v18, s47, v13
    v_mul_u32_u24 v18, 64512, v18
    v_lshl_add_u32 v13, v13, 7, v18
    v_add_u32 v15, 64, v2
    s_mul_i32 s47, s79, 68
    s_add_u32 s47, s47, 0
    v_add_u32 v15, s47, v15
    s_mov_b32 s47, 29826162
    v_mul_hi_u32 v18, s47, v15
    v_mul_u32_u24 v18, 64512, v18
    v_lshl_add_u32 v15, v15, 7, v18
    s_mul_i32 s47, s79, 34
    s_add_u32 s47, s47, 0
    v_add_u32 v14, s47, v2
    s_mov_b32 s47, 59652324
    v_mul_hi_u32 v18, s47, v14
    v_mul_u32_u24 v18, 73728, v18
    v_lshl_add_u32 v14, v14, 7, v18
    v_lshlrev_b32 v3, 4, v2
    v_mov_b32 v24, 1140868096
    v_mov_b32 v25, v24
    v_mov_b32 v26, v24
    v_mov_b32 v27, v24
    s_lshl_b32 s47, s40, 2
    s_add_u32 s52, s24, s47
    s_addc_u32 s53, s25, 0
    s_lshl_b32 s47, s40, 7
    s_add_u32 s47, s47, 4644864
    s_add_u32 s54, s26, s47
    s_addc_u32 s55, s27, 0
    s_mov_b64 exec, 0
    s_branch L_warm1
L_warmed1:
    s_mov_b64 exec, -1
    s_waitcnt vmcnt(0)
    s_barrier
    s_branch L_helper2
L_compute:
    s_mov_b32 s20, s26
    s_and_b32 s21, s27, 0xffff
    s_mov_b32 s22, 4648448
    s_mov_b32 s23, 0x20000
    s_add_u32 s28, s10, s39
    s_addc_u32 s29, s11, 0
    s_and_b32 s29, s29, 0xffff
    s_mov_b32 s30, 1152000
    s_mov_b32 s31, 0x20000
    s_and_b32 s50, s3, 1
    s_lshr_b32 s51, s3, 1
    v_and_b32 v4, 15, v2
    v_lshrrev_b32 v5, 4, v2
    v_mul_u32_u24 v1, 5184, v4
    s_mul_i32 s52, s50, 288
    s_add_u32 s52, s52, 65536
    v_add_u32 v44, s52, v1
    v_and_b32 v6, 1, v5
    v_lshlrev_b32 v6, 4, v6
    v_add_u32 v6, 256, v6
    v_add_u32 v46, v44, v6
    v_lshrrev_b32 v6, 1, v5
    v_mul_u32_u24 v6, 576, v6
    v_sub_u32 v45, v46, v6
    v_mul_u32_u24 v3, 18, v4
    v_add_u32 v3, s50, v3
    v_add_u32 v6, 0, v3
    v_lshrrev_b32 v6, 2, v6
    v_and_b32 v6, 2, v6
    v_xor_b32 v6, v6, v5
    v_lshl_add_u32 v76, v6, 4, v44
    v_add_u32 v6, 2, v3
    v_lshrrev_b32 v6, 2, v6
    v_and_b32 v6, 2, v6
    v_xor_b32 v6, v6, v5
    v_lshl_add_u32 v77, v6, 4, v44
    v_add_u32 v6, 4, v3
    v_lshrrev_b32 v6, 2, v6
    v_and_b32 v6, 2, v6
    v_xor_b32 v6, v6, v5
    v_lshl_add_u32 v78, v6, 4, v44
    v_add_u32 v6, 6, v3
    v_lshrrev_b32 v6, 2, v6
    v_and_b32 v6, 2, v6
    v_xor_b32 v6, v6, v5
    v_lshl_add_u32 v79, v6, 4, v44
    v_add_u32 v6, 8, v3
    v_lshrrev_b32 v6, 2, v6
    v_and_b32 v6, 2, v6
    v_xor_b32 v6, v6, v5
    v_lshl_add_u32 v80, v6, 4, v44
    v_add_u32 v6, 10, v3
    v_lshrrev_b32 v6, 2, v6
    v_and_b32 v6, 2, v6
    v_xor_b32 v6, v6, v5
    v_lshl_add_u32 v81, v6, 4, v44
    v_add_u32 v6, 12, v3
    v_lshrrev_b32 v6, 2, v6
    v_and_b32 v6, 2, v6
    v_xor_b32 v6, v6, v5
    v_lshl_add_u32 v82, v6, 4, v44
    v_add_u32 v6, 14, v3
    v_lshrrev_b32 v6, 2, v6
    v_and_b32 v6, 2, v6
    v_xor_b32 v6, v6, v5
    v_lshl_add_u32 v83, v6, 4, v44
    v_lshlrev_b32 v47, 9, v5
    v_bfe_u32 v6, v2, 2, 2
    v_lshl_add_u32 v47, v6, 6, v47
    v_and_b32 v6, 1, v5
    v_xor_b32 v6, s51, v6
    v_lshl_add_u32 v47, v6, 5, v47
    v_and_b32 v6, 3, v2
    v_lshl_add_u32 v47, v6, 3, v47
    v_and_b32 v6, 31, v2
    v_lshlrev_b32 v52, 4, v6
    v_lshrrev_b32 v6, 5, v2
    v_mul_u32_u24 v3, 18432, v6
    v_add_u32 v48, v52, v3
    v_lshl_add_u32 v52, v6, 3, v52
    v_lshlrev_b32 v6, 31, v6
    v_or_b32 v7, v48, v6
    v_lshlrev_b32 v51, 4, v2
    s_lshl_b32 s53, s41, 1
    s_add_u32 s53, s53, s51
    s_mul_i32 s54, s40, 165888
    s_mul_i32 s55, s50, 9216
    s_add_u32 s54, s54, s55
    s_add_u32 s38, s38, s55
    s_lshl_b32 s55, s53, 9
    s_add_u32 s72, s54, s55
    s_add_u32 s73, s72, 36864
    s_add_u32 s74, s72, 73728
    s_add_u32 s75, s72, 110592
    s_add_u32 s76, s72, 147456
    s_add_u32 s39, s38, 4608
    s_add_u32 s77, s38, 4096
    s_add_u32 s78, s39, 4096
    s_cmp_lt_u32 s53, 9
    s_mov_b32 s56, 3216550459
    s_cselect_b32 s56, 3224939067, s56
    s_cselect_b32 s57, 2.0, 1.0
    s_cselect_b32 s58, -1.0, 0
    v_mov_b32 v49, s57
    v_mov_b32 v50, s58
    s_mov_b32 s57, 1140868096
    s_mov_b32 s58, 0
    s_lshr_b32 s59, s41, 1
    s_lshl_b32 s59, s59, 2
    s_lshr_b32 s59, 419430, s59
    s_and_b32 s59, s59, 15
    v_and_b32 v6, 1, v5
    v_lshlrev_b32 v6, 2, v6
    v_bfe_u32 v3, v2, 2, 2
    v_add_u32 v6, v6, v3
    v_lshrrev_b32 v3, 1, v5
    v_lshl_add_u32 v54, v3, 4, v6
    v_lshl_add_u32 v55, v3, 3, v6
    v_mul_u32_u24 v54, 288, v54
    v_mul_u32_u24 v55, 288, v55
    v_and_b32 v3, 3, v2
    v_lshl_add_u32 v56, v3, 3, v54
    v_lshl_add_u32 v57, v3, 3, v55
    v_lshl_add_u32 v54, v3, 4, v54
    v_lshl_add_u32 v55, v3, 4, v55
    s_lshl_b32 s52, s51, 7
    v_add_u32 v54, s52, v54
    v_add_u32 v55, s52, v55
    s_mul_i32 s53, s43, 288
    s_add_u32 s53, s53, s50
    s_lshl_b32 s55, s41, 1
    s_add_u32 s53, s53, s55
    s_mul_i32 s53, s53, 288
    v_add_u32 v6, s53, v1
    v_lshl_add_u32 v59, v5, 3, v6
    v_lshl_add_u32 v58, v5, 4, v6
    v_add_u32 v58, s52, v58
    s_mul_i32 s55, s50, 5120
    s_add_u32 s55, s55, 65536
    v_add_u32 v53, s55, v51
    s_mul_i32 s55, s50, 288
    s_sub_u32 s53, s53, s55
    s_add_u32 s55, s55, 75776
    v_mul_u32_u24 v6, 592, v4
    v_add_u32 v6, s55, v6
    v_lshl_add_u32 v59, v5, 3, v6
    v_lshl_add_u32 v58, v5, 4, v6
    v_add_u32 v58, s52, v58
    s_mov_b32 s47, 119304648
    v_add_u32 v3, 0, v0
    v_mul_hi_u32 v6, s47, v3
    v_lshlrev_b32 v3, 4, v3
    v_lshl_add_u32 v84, v6, 4, v3
    v_add_u32 v84, 75776, v84
    v_mul_u32_u24 v6, 4608, v6
    v_add3_u32 v87, v6, v3, s53
    v_add_u32 v3, 256, v0
    v_mul_hi_u32 v6, s47, v3
    v_lshlrev_b32 v3, 4, v3
    v_lshl_add_u32 v85, v6, 4, v3
    v_add_u32 v85, 75776, v85
    v_mul_u32_u24 v6, 4608, v6
    v_add3_u32 v88, v6, v3, s53
    v_add_u32 v3, 512, v0
    v_mul_hi_u32 v6, s47, v3
    v_lshlrev_b32 v3, 4, v3
    v_lshl_add_u32 v86, v6, 4, v3
    v_add_u32 v86, 75776, v86
    v_mul_u32_u24 v6, 4608, v6
    v_add3_u32 v89, v6, v3, s53
    s_waitcnt vmcnt(0)
    s_barrier
    ds_read_b128 v[96:99], v82 offset:12672
    ds_read_b64_tr_b16 v[92:93], v47 offset:0
    ds_read_b64_tr_b16 v[94:95], v47 offset:256
    ds_read_b128 v[104:107], v81 offset:12096
    ds_read_b64_tr_b16 v[100:101], v47 offset:2048
    ds_read_b64_tr_b16 v[102:103], v47 offset:2304
    ds_read_b128 v[108:111], v80 offset:11520
    ds_read_b128 v[112:115], v79 offset:10944
    ds_read_b128 v[116:119], v78 offset:10368
    ds_read_b128 v[120:123], v77 offset:9792
    ds_read_b128 v[124:127], v76 offset:9216
    s_waitcnt lgkmcnt(8)
    v_mfma_f32_16x16x32_bf16 v[40:43], v[92:95], v[96:99], 0
    s_waitcnt lgkmcnt(5)
    v_mfma_f32_16x16x32_bf16 v[40:43], v[100:103], v[104:107], v[40:43]
    ds_read_b128 v[96:99], v83 offset:8640
    v_mfma_f32_16x16x32_bf16 v[36:39], v[92:95], v[104:107], 0
    ds_read_b128 v[104:107], v82 offset:8064
    s_waitcnt lgkmcnt(6)
    v_mfma_f32_16x16x32_bf16 v[36:39], v[100:103], v[108:111], v[36:39]
    ds_read_b128 v[128:131], v81 offset:7488
    v_mfma_f32_16x16x32_bf16 v[32:35], v[92:95], v[108:111], 0
    ds_read_b64_tr_b16 v[132:133], v47 offset:4096
    s_waitcnt lgkmcnt(7)
    v_mfma_f32_16x16x32_bf16 v[32:35], v[100:103], v[112:115], v[32:35]
    ds_read_b64_tr_b16 v[134:135], v47 offset:4352
    v_mfma_f32_16x16x32_bf16 v[28:31], v[92:95], v[112:115], 0
    ds_read_b64_tr_b16 v[136:137], v47 offset:6144
    s_waitcnt lgkmcnt(8)
    v_mfma_f32_16x16x32_bf16 v[28:31], v[100:103], v[116:119], v[28:31]
    ds_read_b64_tr_b16 v[138:139], v47 offset:6400
    v_mfma_f32_16x16x32_bf16 v[24:27], v[92:95], v[116:119], 0
    s_waitcnt lgkmcnt(8)
    v_mfma_f32_16x16x32_bf16 v[24:27], v[100:103], v[120:123], v[24:27]
    v_mfma_f32_16x16x32_bf16 v[20:23], v[92:95], v[120:123], 0
    s_waitcnt lgkmcnt(7)
    v_mfma_f32_16x16x32_bf16 v[20:23], v[100:103], v[124:127], v[20:23]
    v_mfma_f32_16x16x32_bf16 v[16:19], v[92:95], v[124:127], 0
    s_waitcnt lgkmcnt(6)
    v_mfma_f32_16x16x32_bf16 v[16:19], v[100:103], v[96:99], v[16:19]
    v_mfma_f32_16x16x32_bf16 v[12:15], v[92:95], v[96:99], 0
    s_waitcnt lgkmcnt(5)
    v_mfma_f32_16x16x32_bf16 v[12:15], v[100:103], v[104:107], v[12:15]
    v_mfma_f32_16x16x32_bf16 v[8:11], v[92:95], v[104:107], 0
    s_waitcnt lgkmcnt(4)
    v_mfma_f32_16x16x32_bf16 v[8:11], v[100:103], v[128:131], v[8:11]
    s_waitcnt lgkmcnt(2)
    s_barrier
    v_mfma_f32_16x16x32_bf16 v[40:43], v[132:135], v[108:111], v[40:43]
    s_waitcnt lgkmcnt(0)
    v_mfma_f32_16x16x32_bf16 v[40:43], v[136:139], v[112:115], v[40:43]
    v_mfma_f32_16x16x32_bf16 v[36:39], v[132:135], v[112:115], v[36:39]
    ds_read_b128 v[92:95], v80 offset:6912
    v_mfma_f32_16x16x32_bf16 v[36:39], v[136:139], v[116:119], v[36:39]
    ds_read_b128 v[100:103], v79 offset:6336
    v_mfma_f32_16x16x32_bf16 v[32:35], v[132:135], v[116:119], v[32:35]
    ds_read_b64_tr_b16 v[108:109], v47 offset:8192
    v_mfma_f32_16x16x32_bf16 v[32:35], v[136:139], v[120:123], v[32:35]
    ds_read_b64_tr_b16 v[110:111], v47 offset:8448
    v_mfma_f32_16x16x32_bf16 v[28:31], v[132:135], v[120:123], v[28:31]
    ds_read_b64_tr_b16 v[112:113], v47 offset:10240
    v_mfma_f32_16x16x32_bf16 v[28:31], v[136:139], v[124:127], v[28:31]
    ds_read_b64_tr_b16 v[114:115], v47 offset:10496
    v_mfma_f32_16x16x32_bf16 v[24:27], v[132:135], v[124:127], v[24:27]
    v_mfma_f32_16x16x32_bf16 v[24:27], v[136:139], v[96:99], v[24:27]
    v_mfma_f32_16x16x32_bf16 v[20:23], v[132:135], v[96:99], v[20:23]
    v_mfma_f32_16x16x32_bf16 v[20:23], v[136:139], v[104:107], v[20:23]
    v_mfma_f32_16x16x32_bf16 v[16:19], v[132:135], v[104:107], v[16:19]
    v_mfma_f32_16x16x32_bf16 v[16:19], v[136:139], v[128:131], v[16:19]
    v_mfma_f32_16x16x32_bf16 v[12:15], v[132:135], v[128:131], v[12:15]
    s_waitcnt lgkmcnt(5)
    v_mfma_f32_16x16x32_bf16 v[12:15], v[136:139], v[92:95], v[12:15]
    v_mfma_f32_16x16x32_bf16 v[8:11], v[132:135], v[92:95], v[8:11]
    s_waitcnt lgkmcnt(4)
    v_mfma_f32_16x16x32_bf16 v[8:11], v[136:139], v[100:103], v[8:11]
    s_waitcnt lgkmcnt(2)
    v_mfma_f32_16x16x32_bf16 v[40:43], v[108:111], v[116:119], v[40:43]
    s_waitcnt lgkmcnt(0)
    v_mfma_f32_16x16x32_bf16 v[40:43], v[112:115], v[120:123], v[40:43]
    v_mfma_f32_16x16x32_bf16 v[36:39], v[108:111], v[120:123], v[36:39]
    ds_read_b128 v[116:119], v78 offset:5760
    v_mfma_f32_16x16x32_bf16 v[36:39], v[112:115], v[124:127], v[36:39]
    ds_read_b128 v[120:123], v77 offset:5184
    v_mfma_f32_16x16x32_bf16 v[32:35], v[108:111], v[124:127], v[32:35]
    ds_read_b64_tr_b16 v[132:133], v47 offset:12288
    v_mfma_f32_16x16x32_bf16 v[32:35], v[112:115], v[96:99], v[32:35]
    ds_read_b64_tr_b16 v[134:135], v47 offset:12544
    v_mfma_f32_16x16x32_bf16 v[28:31], v[108:111], v[96:99], v[28:31]
    ds_read_b64_tr_b16 v[136:137], v47 offset:14336
    v_mfma_f32_16x16x32_bf16 v[28:31], v[112:115], v[104:107], v[28:31]
    ds_read_b64_tr_b16 v[138:139], v47 offset:14592
    v_mfma_f32_16x16x32_bf16 v[24:27], v[108:111], v[104:107], v[24:27]
    v_mfma_f32_16x16x32_bf16 v[24:27], v[112:115], v[128:131], v[24:27]
    v_mfma_f32_16x16x32_bf16 v[20:23], v[108:111], v[128:131], v[20:23]
    v_mfma_f32_16x16x32_bf16 v[20:23], v[112:115], v[92:95], v[20:23]
    v_mfma_f32_16x16x32_bf16 v[16:19], v[108:111], v[92:95], v[16:19]
    v_mfma_f32_16x16x32_bf16 v[16:19], v[112:115], v[100:103], v[16:19]
    v_mfma_f32_16x16x32_bf16 v[12:15], v[108:111], v[100:103], v[12:15]
    s_waitcnt lgkmcnt(5)
    v_mfma_f32_16x16x32_bf16 v[12:15], v[112:115], v[116:119], v[12:15]
    v_mfma_f32_16x16x32_bf16 v[8:11], v[108:111], v[116:119], v[8:11]
    s_waitcnt lgkmcnt(4)
    v_mfma_f32_16x16x32_bf16 v[8:11], v[112:115], v[120:123], v[8:11]
    s_waitcnt lgkmcnt(2)
    v_mfma_f32_16x16x32_bf16 v[40:43], v[132:135], v[124:127], v[40:43]
    s_waitcnt lgkmcnt(0)
    v_mfma_f32_16x16x32_bf16 v[40:43], v[136:139], v[96:99], v[40:43]
    s_barrier
    v_mfma_f32_16x16x32_bf16 v[36:39], v[132:135], v[96:99], v[36:39]
    ds_read_b128 v[96:99], v76 offset:4608
    v_mfma_f32_16x16x32_bf16 v[36:39], v[136:139], v[104:107], v[36:39]
    ds_read_b128 v[108:111], v83 offset:4032
    v_mfma_f32_16x16x32_bf16 v[32:35], v[132:135], v[104:107], v[32:35]
    ds_read_b64_tr_b16 v[112:113], v47 offset:16384
    v_mfma_f32_16x16x32_bf16 v[32:35], v[136:139], v[128:131], v[32:35]
    ds_read_b64_tr_b16 v[114:115], v47 offset:16640
    v_mfma_f32_16x16x32_bf16 v[28:31], v[132:135], v[128:131], v[28:31]
    ds_read_b64_tr_b16 v[124:125], v47 offset:18432
    v_mfma_f32_16x16x32_bf16 v[28:31], v[136:139], v[92:95], v[28:31]
    ds_read_b64_tr_b16 v[126:127], v47 offset:18688
    v_mfma_f32_16x16x32_bf16 v[24:27], v[132:135], v[92:95], v[24:27]
    v_mfma_f32_16x16x32_bf16 v[24:27], v[136:139], v[100:103], v[24:27]
    v_mfma_f32_16x16x32_bf16 v[20:23], v[132:135], v[100:103], v[20:23]
    v_mfma_f32_16x16x32_bf16 v[20:23], v[136:139], v[116:119], v[20:23]
    v_mfma_f32_16x16x32_bf16 v[16:19], v[132:135], v[116:119], v[16:19]
    v_mfma_f32_16x16x32_bf16 v[16:19], v[136:139], v[120:123], v[16:19]
    v_mfma_f32_16x16x32_bf16 v[12:15], v[132:135], v[120:123], v[12:15]
    s_waitcnt lgkmcnt(5)
    v_mfma_f32_16x16x32_bf16 v[12:15], v[136:139], v[96:99], v[12:15]
    v_mfma_f32_16x16x32_bf16 v[8:11], v[132:135], v[96:99], v[8:11]
    s_waitcnt lgkmcnt(4)
    v_mfma_f32_16x16x32_bf16 v[8:11], v[136:139], v[108:111], v[8:11]
    s_waitcnt lgkmcnt(2)
    v_mfma_f32_16x16x32_bf16 v[40:43], v[112:115], v[104:107], v[40:43]
    s_waitcnt lgkmcnt(0)
    v_mfma_f32_16x16x32_bf16 v[40:43], v[124:127], v[128:131], v[40:43]
    v_mfma_f32_16x16x32_bf16 v[36:39], v[112:115], v[128:131], v[36:39]
    ds_read_b128 v[104:107], v82 offset:3456
    v_mfma_f32_16x16x32_bf16 v[36:39], v[124:127], v[92:95], v[36:39]
    ds_read_b128 v[128:131], v81 offset:2880
    v_mfma_f32_16x16x32_bf16 v[32:35], v[112:115], v[92:95], v[32:35]
    ds_read_b64_tr_b16 v[132:133], v47 offset:20480
    v_mfma_f32_16x16x32_bf16 v[32:35], v[124:127], v[100:103], v[32:35]
    ds_read_b64_tr_b16 v[134:135], v47 offset:20736
    v_mfma_f32_16x16x32_bf16 v[28:31], v[112:115], v[100:103], v[28:31]
    ds_read_b64_tr_b16 v[136:137], v47 offset:22528
    v_mfma_f32_16x16x32_bf16 v[28:31], v[124:127], v[116:119], v[28:31]
    ds_read_b64_tr_b16 v[138:139], v47 offset:22784
    v_mfma_f32_16x16x32_bf16 v[24:27], v[112:115], v[116:119], v[24:27]
    v_mfma_f32_16x16x32_bf16 v[24:27], v[124:127], v[120:123], v[24:27]
    v_mfma_f32_16x16x32_bf16 v[20:23], v[112:115], v[120:123], v[20:23]
    v_mfma_f32_16x16x32_bf16 v[20:23], v[124:127], v[96:99], v[20:23]
    v_mfma_f32_16x16x32_bf16 v[16:19], v[112:115], v[96:99], v[16:19]
    v_mfma_f32_16x16x32_bf16 v[16:19], v[124:127], v[108:111], v[16:19]
    v_mfma_f32_16x16x32_bf16 v[12:15], v[112:115], v[108:111], v[12:15]
    s_waitcnt lgkmcnt(5)
    v_mfma_f32_16x16x32_bf16 v[12:15], v[124:127], v[104:107], v[12:15]
    v_mfma_f32_16x16x32_bf16 v[8:11], v[112:115], v[104:107], v[8:11]
    s_waitcnt lgkmcnt(4)
    v_mfma_f32_16x16x32_bf16 v[8:11], v[124:127], v[128:131], v[8:11]
    s_waitcnt lgkmcnt(2)
    v_mfma_f32_16x16x32_bf16 v[40:43], v[132:135], v[92:95], v[40:43]
    s_waitcnt lgkmcnt(0)
    v_mfma_f32_16x16x32_bf16 v[40:43], v[136:139], v[100:103], v[40:43]
    v_mfma_f32_16x16x32_bf16 v[36:39], v[132:135], v[100:103], v[36:39]
    ds_read_b128 v[92:95], v80 offset:2304
    v_mfma_f32_16x16x32_bf16 v[36:39], v[136:139], v[116:119], v[36:39]
    ds_read_b128 v[100:103], v79 offset:1728
    v_mfma_f32_16x16x32_bf16 v[32:35], v[132:135], v[116:119], v[32:35]
    ds_read_b64_tr_b16 v[112:113], v47 offset:24576
    v_mfma_f32_16x16x32_bf16 v[32:35], v[136:139], v[120:123], v[32:35]
    ds_read_b64_tr_b16 v[114:115], v47 offset:24832
    v_mfma_f32_16x16x32_bf16 v[28:31], v[132:135], v[120:123], v[28:31]
    ds_read_b64_tr_b16 v[124:125], v47 offset:26624
    v_mfma_f32_16x16x32_bf16 v[28:31], v[136:139], v[96:99], v[28:31]
    ds_read_b64_tr_b16 v[126:127], v47 offset:26880
    v_mfma_f32_16x16x32_bf16 v[24:27], v[132:135], v[96:99], v[24:27]
    v_mfma_f32_16x16x32_bf16 v[24:27], v[136:139], v[108:111], v[24:27]
    v_mfma_f32_16x16x32_bf16 v[20:23], v[132:135], v[108:111], v[20:23]
    v_mfma_f32_16x16x32_bf16 v[20:23], v[136:139], v[104:107], v[20:23]
    v_mfma_f32_16x16x32_bf16 v[16:19], v[132:135], v[104:107], v[16:19]
    v_mfma_f32_16x16x32_bf16 v[16:19], v[136:139], v[128:131], v[16:19]
    v_mfma_f32_16x16x32_bf16 v[12:15], v[132:135], v[128:131], v[12:15]
    s_waitcnt lgkmcnt(5)
    v_mfma_f32_16x16x32_bf16 v[12:15], v[136:139], v[92:95], v[12:15]
    v_mfma_f32_16x16x32_bf16 v[8:11], v[132:135], v[92:95], v[8:11]
    s_waitcnt lgkmcnt(4)
    v_mfma_f32_16x16x32_bf16 v[8:11], v[136:139], v[100:103], v[8:11]
    s_waitcnt lgkmcnt(2)
    v_mfma_f32_16x16x32_bf16 v[40:43], v[112:115], v[116:119], v[40:43]
    s_waitcnt lgkmcnt(0)
    v_mfma_f32_16x16x32_bf16 v[40:43], v[124:127], v[120:123], v[40:43]
    ds_read_b128 v[116:119], v78 offset:1152
    s_barrier
    v_mfma_f32_16x16x32_bf16 v[36:39], v[112:115], v[120:123], v[36:39]
    ds_read_b128 v[120:123], v77 offset:576
    v_mfma_f32_16x16x32_bf16 v[36:39], v[124:127], v[96:99], v[36:39]
    ds_read_b64_tr_b16 v[132:133], v47 offset:28672
    v_mfma_f32_16x16x32_bf16 v[32:35], v[112:115], v[96:99], v[32:35]
    ds_read_b64_tr_b16 v[134:135], v47 offset:28928
    v_mfma_f32_16x16x32_bf16 v[32:35], v[124:127], v[108:111], v[32:35]
    ds_read_b128 v[136:139], v82 offset:12736
    v_mfma_f32_16x16x32_bf16 v[28:31], v[112:115], v[108:111], v[28:31]
    ds_read_b64_tr_b16 v[140:141], v47 offset:30720
    v_mfma_f32_16x16x32_bf16 v[28:31], v[124:127], v[104:107], v[28:31]
    ds_read_b64_tr_b16 v[142:143], v47 offset:30976
    v_mfma_f32_16x16x32_bf16 v[24:27], v[112:115], v[104:107], v[24:27]
    v_mfma_f32_16x16x32_bf16 v[24:27], v[124:127], v[128:131], v[24:27]
    ds_read_b128 v[144:147], v81 offset:12160
    v_mfma_f32_16x16x32_bf16 v[20:23], v[112:115], v[128:131], v[20:23]
    v_mfma_f32_16x16x32_bf16 v[20:23], v[124:127], v[92:95], v[20:23]
    ds_read_b128 v[148:151], v80 offset:11584
    v_mfma_f32_16x16x32_bf16 v[16:19], v[112:115], v[92:95], v[16:19]
    v_mfma_f32_16x16x32_bf16 v[16:19], v[124:127], v[100:103], v[16:19]
    ds_read_b128 v[152:155], v79 offset:11008
    v_mfma_f32_16x16x32_bf16 v[12:15], v[112:115], v[100:103], v[12:15]
    s_waitcnt lgkmcnt(9)
    v_mfma_f32_16x16x32_bf16 v[12:15], v[124:127], v[116:119], v[12:15]
    ds_read_b128 v[156:159], v78 offset:10432
    v_mfma_f32_16x16x32_bf16 v[8:11], v[112:115], v[116:119], v[8:11]
    s_waitcnt lgkmcnt(9)
    v_mfma_f32_16x16x32_bf16 v[8:11], v[124:127], v[120:123], v[8:11]
    ds_read_b128 v[112:115], v77 offset:9856
    s_waitcnt lgkmcnt(8)
    v_mfma_f32_16x16x32_bf16 v[40:43], v[132:135], v[96:99], v[40:43]
    ds_read_b128 v[96:99], v76 offset:9280
    s_waitcnt lgkmcnt(6)
    v_mfma_f32_16x16x32_bf16 v[40:43], v[140:143], v[136:139], v[40:43]
    ds_read_b128 v[124:127], v83 offset:8704
    v_mfma_f32_16x16x32_bf16 v[36:39], v[132:135], v[108:111], v[36:39]
    ds_read_b128 v[108:111], v76 offset:0
    s_waitcnt lgkmcnt(7)
    v_mfma_f32_16x16x32_bf16 v[36:39], v[140:143], v[144:147], v[36:39]
    ds_read_b128 v[136:139], v82 offset:8128
    v_mfma_f32_16x16x32_bf16 v[32:35], v[132:135], v[104:107], v[32:35]
    ds_read_b64_tr_b16 v[104:105], v47 offset:32768
    s_waitcnt lgkmcnt(8)
    v_mfma_f32_16x16x32_bf16 v[32:35], v[140:143], v[148:151], v[32:35]
    ds_read_b64_tr_b16 v[106:107], v47 offset:33024
    v_mfma_f32_16x16x32_bf16 v[28:31], v[132:135], v[128:131], v[28:31]
    ds_read_b64_tr_b16 v[128:129], v47 offset:34816
    s_waitcnt lgkmcnt(9)
    v_mfma_f32_16x16x32_bf16 v[28:31], v[140:143], v[152:155], v[28:31]
    ds_read_b64_tr_b16 v[130:131], v47 offset:35072
    v_mfma_f32_16x16x32_bf16 v[24:27], v[132:135], v[92:95], v[24:27]
    s_waitcnt lgkmcnt(9)
    v_mfma_f32_16x16x32_bf16 v[24:27], v[140:143], v[156:159], v[24:27]
    v_mfma_f32_16x16x32_bf16 v[20:23], v[132:135], v[100:103], v[20:23]
    s_waitcnt lgkmcnt(8)
    v_mfma_f32_16x16x32_bf16 v[20:23], v[140:143], v[112:115], v[20:23]
    v_mfma_f32_16x16x32_bf16 v[16:19], v[132:135], v[116:119], v[16:19]
    s_waitcnt lgkmcnt(7)
    v_mfma_f32_16x16x32_bf16 v[16:19], v[140:143], v[96:99], v[16:19]
    v_mfma_f32_16x16x32_bf16 v[12:15], v[132:135], v[120:123], v[12:15]
    s_waitcnt lgkmcnt(6)
    v_mfma_f32_16x16x32_bf16 v[12:15], v[140:143], v[124:127], v[12:15]
    s_waitcnt lgkmcnt(5)
    v_mfma_f32_16x16x32_bf16 v[8:11], v[132:135], v[108:111], v[8:11]
    s_waitcnt lgkmcnt(4)
    v_mfma_f32_16x16x32_bf16 v[8:11], v[140:143], v[136:139], v[8:11]
    s_waitcnt lgkmcnt(2)
    v_mfma_f32_16x16x32_bf16 v[40:43], v[104:107], v[144:147], v[40:43]
    s_waitcnt lgkmcnt(0)
    v_mfma_f32_16x16x32_bf16 v[40:43], v[128:131], v[148:151], v[40:43]
    v_mfma_f32_16x16x32_bf16 v[36:39], v[104:107], v[148:151], v[36:39]
    ds_read_b128 v[92:95], v81 offset:7552
    v_mfma_f32_16x16x32_bf16 v[36:39], v[128:131], v[152:155], v[36:39]
    ds_read_b128 v[100:103], v80 offset:6976
    v_mfma_f32_16x16x32_bf16 v[32:35], v[104:107], v[152:155], v[32:35]
    ds_read_b64_tr_b16 v[108:109], v47 offset:36864
    v_mfma_f32_16x16x32_bf16 v[32:35], v[128:131], v[156:159], v[32:35]
    ds_read_b64_tr_b16 v[110:111], v47 offset:37120
    v_mfma_f32_16x16x32_bf16 v[28:31], v[104:107], v[156:159], v[28:31]
    ds_read_b64_tr_b16 v[116:117], v47 offset:38912
    v_mfma_f32_16x16x32_bf16 v[28:31], v[128:131], v[112:115], v[28:31]
    ds_read_b64_tr_b16 v[118:119], v47 offset:39168
    v_mfma_f32_16x16x32_bf16 v[24:27], v[104:107], v[112:115], v[24:27]
    v_mfma_f32_16x16x32_bf16 v[24:27], v[128:131], v[96:99], v[24:27]
    v_mfma_f32_16x16x32_bf16 v[20:23], v[104:107], v[96:99], v[20:23]
    v_mfma_f32_16x16x32_bf16 v[20:23], v[128:131], v[124:127], v[20:23]
    v_mfma_f32_16x16x32_bf16 v[16:19], v[104:107], v[124:127], v[16:19]
    v_mfma_f32_16x16x32_bf16 v[16:19], v[128:131], v[136:139], v[16:19]
    v_mfma_f32_16x16x32_bf16 v[12:15], v[104:107], v[136:139], v[12:15]
    s_waitcnt lgkmcnt(5)
    v_mfma_f32_16x16x32_bf16 v[12:15], v[128:131], v[92:95], v[12:15]
    v_mfma_f32_16x16x32_bf16 v[8:11], v[104:107], v[92:95], v[8:11]
    s_waitcnt lgkmcnt(4)
    v_mfma_f32_16x16x32_bf16 v[8:11], v[128:131], v[100:103], v[8:11]
    s_waitcnt lgkmcnt(2)
    v_mfma_f32_16x16x32_bf16 v[40:43], v[108:111], v[152:155], v[40:43]
    s_waitcnt lgkmcnt(0)
    v_mfma_f32_16x16x32_bf16 v[40:43], v[116:119], v[156:159], v[40:43]
    s_barrier
    v_mfma_f32_16x16x32_bf16 v[36:39], v[108:111], v[156:159], v[36:39]
    ds_read_b128 v[104:107], v79 offset:6400
    v_mfma_f32_16x16x32_bf16 v[36:39], v[116:119], v[112:115], v[36:39]
    ds_read_b128 v[120:123], v78 offset:5824
    v_mfma_f32_16x16x32_bf16 v[32:35], v[108:111], v[112:115], v[32:35]
    ds_read_b64_tr_b16 v[128:129], v47 offset:40960
    v_mfma_f32_16x16x32_bf16 v[32:35], v[116:119], v[96:99], v[32:35]
    ds_read_b64_tr_b16 v[130:131], v47 offset:41216
    v_mfma_f32_16x16x32_bf16 v[28:31], v[108:111], v[96:99], v[28:31]
    ds_read_b64_tr_b16 v[132:133], v47 offset:43008
    v_mfma_f32_16x16x32_bf16 v[28:31], v[116:119], v[124:127], v[28:31]
    ds_read_b64_tr_b16 v[134:135], v47 offset:43264
    v_mfma_f32_16x16x32_bf16 v[24:27], v[108:111], v[124:127], v[24:27]
    v_mfma_f32_16x16x32_bf16 v[24:27], v[116:119], v[136:139], v[24:27]
    v_mfma_f32_16x16x32_bf16 v[20:23], v[108:111], v[136:139], v[20:23]
    v_mfma_f32_16x16x32_bf16 v[20:23], v[116:119], v[92:95], v[20:23]
    v_mfma_f32_16x16x32_bf16 v[16:19], v[108:111], v[92:95], v[16:19]
    v_mfma_f32_16x16x32_bf16 v[16:19], v[116:119], v[100:103], v[16:19]
    v_mfma_f32_16x16x32_bf16 v[12:15], v[108:111], v[100:103], v[12:15]
    s_waitcnt lgkmcnt(5)
    v_mfma_f32_16x16x32_bf16 v[12:15], v[116:119], v[104:107], v[12:15]
    v_mfma_f32_16x16x32_bf16 v[8:11], v[108:111], v[104:107], v[8:11]
    s_waitcnt lgkmcnt(4)
    v_mfma_f32_16x16x32_bf16 v[8:11], v[116:119], v[120:123], v[8:11]
    s_waitcnt lgkmcnt(2)
    v_mfma_f32_16x16x32_bf16 v[40:43], v[128:131], v[112:115], v[40:43]
    s_waitcnt lgkmcnt(0)
    v_mfma_f32_16x16x32_bf16 v[40:43], v[132:135], v[96:99], v[40:43]
    v_mfma_f32_16x16x32_bf16 v[36:39], v[128:131], v[96:99], v[36:39]
    ds_read_b128 v[96:99], v77 offset:5248
    v_mfma_f32_16x16x32_bf16 v[36:39], v[132:135], v[124:127], v[36:39]
    ds_read_b128 v[108:111], v76 offset:4672
    v_mfma_f32_16x16x32_bf16 v[32:35], v[128:131], v[124:127], v[32:35]
    ds_read_b64_tr_b16 v[112:113], v47 offset:45056
    v_mfma_f32_16x16x32_bf16 v[32:35], v[132:135], v[136:139], v[32:35]
    ds_read_b64_tr_b16 v[114:115], v47 offset:45312
    v_mfma_f32_16x16x32_bf16 v[28:31], v[128:131], v[136:139], v[28:31]
    ds_read_b64_tr_b16 v[116:117], v47 offset:47104
    v_mfma_f32_16x16x32_bf16 v[28:31], v[132:135], v[92:95], v[28:31]
    ds_read_b64_tr_b16 v[118:119], v47 offset:47360
    v_mfma_f32_16x16x32_bf16 v[24:27], v[128:131], v[92:95], v[24:27]
    v_mfma_f32_16x16x32_bf16 v[24:27], v[132:135], v[100:103], v[24:27]
    v_mfma_f32_16x16x32_bf16 v[20:23], v[128:131], v[100:103], v[20:23]
    v_mfma_f32_16x16x32_bf16 v[20:23], v[132:135], v[104:107], v[20:23]
    v_mfma_f32_16x16x32_bf16 v[16:19], v[128:131], v[104:107], v[16:19]
    v_mfma_f32_16x16x32_bf16 v[16:19], v[132:135], v[120:123], v[16:19]
    v_mfma_f32_16x16x32_bf16 v[12:15], v[128:131], v[120:123], v[12:15]
    s_waitcnt lgkmcnt(5)
    v_mfma_f32_16x16x32_bf16 v[12:15], v[132:135], v[96:99], v[12:15]
    v_mfma_f32_16x16x32_bf16 v[8:11], v[128:131], v[96:99], v[8:11]
    s_waitcnt lgkmcnt(4)
    v_mfma_f32_16x16x32_bf16 v[8:11], v[132:135], v[108:111], v[8:11]
    s_waitcnt lgkmcnt(2)
    v_mfma_f32_16x16x32_bf16 v[40:43], v[112:115], v[124:127], v[40:43]
    s_waitcnt lgkmcnt(0)
    v_mfma_f32_16x16x32_bf16 v[40:43], v[116:119], v[136:139], v[40:43]
    v_mfma_f32_16x16x32_bf16 v[36:39], v[112:115], v[136:139], v[36:39]
    ds_read_b128 v[124:127], v83 offset:4096
    v_mfma_f32_16x16x32_bf16 v[36:39], v[116:119], v[92:95], v[36:39]
    ds_read_b128 v[128:131], v82 offset:3520
    v_mfma_f32_16x16x32_bf16 v[32:35], v[112:115], v[92:95], v[32:35]
    ds_read_b64_tr_b16 v[132:133], v47 offset:49152
    v_mfma_f32_16x16x32_bf16 v[32:35], v[116:119], v[100:103], v[32:35]
    ds_read_b64_tr_b16 v[134:135], v47 offset:49408
    v_mfma_f32_16x16x32_bf16 v[28:31], v[112:115], v[100:103], v[28:31]
    ds_read_b64_tr_b16 v[136:137], v47 offset:51200
    v_mfma_f32_16x16x32_bf16 v[28:31], v[116:119], v[104:107], v[28:31]
    ds_read_b64_tr_b16 v[138:139], v47 offset:51456
    v_mfma_f32_16x16x32_bf16 v[24:27], v[112:115], v[104:107], v[24:27]
    v_mfma_f32_16x16x32_bf16 v[24:27], v[116:119], v[120:123], v[24:27]
    v_mfma_f32_16x16x32_bf16 v[20:23], v[112:115], v[120:123], v[20:23]
    v_mfma_f32_16x16x32_bf16 v[20:23], v[116:119], v[96:99], v[20:23]
    v_mfma_f32_16x16x32_bf16 v[16:19], v[112:115], v[96:99], v[16:19]
    v_mfma_f32_16x16x32_bf16 v[16:19], v[116:119], v[108:111], v[16:19]
    v_mfma_f32_16x16x32_bf16 v[12:15], v[112:115], v[108:111], v[12:15]
    s_waitcnt lgkmcnt(5)
    v_mfma_f32_16x16x32_bf16 v[12:15], v[116:119], v[124:127], v[12:15]
    v_mfma_f32_16x16x32_bf16 v[8:11], v[112:115], v[124:127], v[8:11]
    s_waitcnt lgkmcnt(4)
    v_mfma_f32_16x16x32_bf16 v[8:11], v[116:119], v[128:131], v[8:11]
    s_waitcnt lgkmcnt(2)
    v_mfma_f32_16x16x32_bf16 v[40:43], v[132:135], v[92:95], v[40:43]
    s_waitcnt lgkmcnt(0)
    v_mfma_f32_16x16x32_bf16 v[40:43], v[136:139], v[100:103], v[40:43]
    s_barrier
    v_mfma_f32_16x16x32_bf16 v[36:39], v[132:135], v[100:103], v[36:39]
    ds_read_b128 v[92:95], v81 offset:2944
    v_mfma_f32_16x16x32_bf16 v[36:39], v[136:139], v[104:107], v[36:39]
    ds_read_b128 v[100:103], v80 offset:2368
    v_mfma_f32_16x16x32_bf16 v[32:35], v[132:135], v[104:107], v[32:35]
    ds_read_b64_tr_b16 v[112:113], v47 offset:53248
    v_mfma_f32_16x16x32_bf16 v[32:35], v[136:139], v[120:123], v[32:35]
    ds_read_b64_tr_b16 v[114:115], v47 offset:53504
    v_mfma_f32_16x16x32_bf16 v[28:31], v[132:135], v[120:123], v[28:31]
    ds_read_b64_tr_b16 v[116:117], v47 offset:55296
    v_mfma_f32_16x16x32_bf16 v[28:31], v[136:139], v[96:99], v[28:31]
    ds_read_b64_tr_b16 v[118:119], v47 offset:55552
    v_mfma_f32_16x16x32_bf16 v[24:27], v[132:135], v[96:99], v[24:27]
    v_mfma_f32_16x16x32_bf16 v[24:27], v[136:139], v[108:111], v[24:27]
    v_mfma_f32_16x16x32_bf16 v[20:23], v[132:135], v[108:111], v[20:23]
    v_mfma_f32_16x16x32_bf16 v[20:23], v[136:139], v[124:127], v[20:23]
    v_mfma_f32_16x16x32_bf16 v[16:19], v[132:135], v[124:127], v[16:19]
    v_mfma_f32_16x16x32_bf16 v[16:19], v[136:139], v[128:131], v[16:19]
    v_mfma_f32_16x16x32_bf16 v[12:15], v[132:135], v[128:131], v[12:15]
L_warm1:
    s_cbranch_execz L_warmed1
    s_waitcnt lgkmcnt(5)
    v_mfma_f32_16x16x32_bf16 v[12:15], v[136:139], v[92:95], v[12:15]
    v_mfma_f32_16x16x32_bf16 v[8:11], v[132:135], v[92:95], v[8:11]
    s_waitcnt lgkmcnt(4)
    v_mfma_f32_16x16x32_bf16 v[8:11], v[136:139], v[100:103], v[8:11]
    s_waitcnt lgkmcnt(2)
    v_mfma_f32_16x16x32_bf16 v[40:43], v[112:115], v[104:107], v[40:43]
    s_waitcnt lgkmcnt(0)
    v_mfma_f32_16x16x32_bf16 v[40:43], v[116:119], v[120:123], v[40:43]
    v_mfma_f32_16x16x32_bf16 v[36:39], v[112:115], v[120:123], v[36:39]
    ds_read_b128 v[104:107], v79 offset:1792
    v_mfma_f32_16x16x32_bf16 v[36:39], v[116:119], v[96:99], v[36:39]
    ds_read_b128 v[120:123], v78 offset:1216
    v_mfma_f32_16x16x32_bf16 v[32:35], v[112:115], v[96:99], v[32:35]
    ds_read_b64_tr_b16 v[132:133], v47 offset:57344
    v_mfma_f32_16x16x32_bf16 v[32:35], v[116:119], v[108:111], v[32:35]
    ds_read_b64_tr_b16 v[134:135], v47 offset:57600
    v_mfma_f32_16x16x32_bf16 v[28:31], v[112:115], v[108:111], v[28:31]
    ds_read_b64_tr_b16 v[136:137], v47 offset:59392
    v_mfma_f32_16x16x32_bf16 v[28:31], v[116:119], v[124:127], v[28:31]
    ds_read_b64_tr_b16 v[138:139], v47 offset:59648
    v_mfma_f32_16x16x32_bf16 v[24:27], v[112:115], v[124:127], v[24:27]
    v_mfma_f32_16x16x32_bf16 v[24:27], v[116:119], v[128:131], v[24:27]
    v_mfma_f32_16x16x32_bf16 v[20:23], v[112:115], v[128:131], v[20:23]
    v_mfma_f32_16x16x32_bf16 v[20:23], v[116:119], v[92:95], v[20:23]
    v_mfma_f32_16x16x32_bf16 v[16:19], v[112:115], v[92:95], v[16:19]
    v_mfma_f32_16x16x32_bf16 v[16:19], v[116:119], v[100:103], v[16:19]
    v_mfma_f32_16x16x32_bf16 v[12:15], v[112:115], v[100:103], v[12:15]
    s_waitcnt lgkmcnt(5)
    v_mfma_f32_16x16x32_bf16 v[12:15], v[116:119], v[104:107], v[12:15]
    v_mfma_f32_16x16x32_bf16 v[8:11], v[112:115], v[104:107], v[8:11]
    s_waitcnt lgkmcnt(4)
    v_mfma_f32_16x16x32_bf16 v[8:11], v[116:119], v[120:123], v[8:11]
    s_waitcnt lgkmcnt(2)
    v_mfma_f32_16x16x32_bf16 v[40:43], v[132:135], v[96:99], v[40:43]
    ds_read_b128 v[96:99], v77 offset:640
    s_waitcnt lgkmcnt(1)
    v_mfma_f32_16x16x32_bf16 v[40:43], v[136:139], v[108:111], v[40:43]
    ds_read_b128 v[112:115], v76 offset:64
    v_mfma_f32_16x16x32_bf16 v[36:39], v[132:135], v[108:111], v[36:39]
    ds_read_b128 v[108:111], v45 offset:12672
    v_mfma_f32_16x16x32_bf16 v[36:39], v[136:139], v[124:127], v[36:39]
    ds_read_b64_tr_b16 v[116:117], v47 offset:61440
    v_mfma_f32_16x16x32_bf16 v[32:35], v[132:135], v[124:127], v[32:35]
    ds_read_b64_tr_b16 v[118:119], v47 offset:61696
    v_mfma_f32_16x16x32_bf16 v[32:35], v[136:139], v[128:131], v[32:35]
    ds_read_b128 v[124:127], v45 offset:11520
    v_mfma_f32_16x16x32_bf16 v[28:31], v[132:135], v[128:131], v[28:31]
    ds_read_b64_tr_b16 v[128:129], v47 offset:63488
    v_mfma_f32_16x16x32_bf16 v[28:31], v[136:139], v[92:95], v[28:31]
    ds_read_b64_tr_b16 v[130:131], v47 offset:63744
    v_mfma_f32_16x16x32_bf16 v[24:27], v[132:135], v[92:95], v[24:27]
    ds_read_b128 v[92:95], v45 offset:12096
    v_mfma_f32_16x16x32_bf16 v[24:27], v[136:139], v[100:103], v[24:27]
    ds_read_b128 v[140:143], v45 offset:10944
    v_mfma_f32_16x16x32_bf16 v[20:23], v[132:135], v[100:103], v[20:23]
    v_mfma_f32_16x16x32_bf16 v[20:23], v[136:139], v[104:107], v[20:23]
    ds_read_b128 v[100:103], v45 offset:10368
    v_mfma_f32_16x16x32_bf16 v[16:19], v[132:135], v[104:107], v[16:19]
    v_mfma_f32_16x16x32_bf16 v[16:19], v[136:139], v[120:123], v[16:19]
    ds_read_b128 v[104:107], v45 offset:9792
    v_mfma_f32_16x16x32_bf16 v[12:15], v[132:135], v[120:123], v[12:15]
    s_waitcnt lgkmcnt(11)
    v_mfma_f32_16x16x32_bf16 v[12:15], v[136:139], v[96:99], v[12:15]
    ds_read_b128 v[120:123], v45 offset:9216
    v_mfma_f32_16x16x32_bf16 v[8:11], v[132:135], v[96:99], v[8:11]
    s_waitcnt lgkmcnt(11)
    v_mfma_f32_16x16x32_bf16 v[8:11], v[136:139], v[112:115], v[8:11]
    ds_read_b128 v[96:99], v45 offset:8640
    s_waitcnt lgkmcnt(9)
    v_mfma_f32_16x16x32_bf16 v[40:43], v[116:119], v[108:111], v[40:43]
    s_waitcnt lgkmcnt(6)
    v_mfma_f32_16x16x32_bf16 v[40:43], v[128:131], v[124:127], v[40:43]
    ds_read_b128 v[108:111], v45 offset:8064
    s_waitcnt lgkmcnt(6)
    s_barrier
    v_mfma_f32_16x16x32_bf16 v[36:39], v[116:119], v[92:95], v[36:39]
    ds_read_b128 v[92:95], v45 offset:7488
    s_waitcnt lgkmcnt(6)
    v_mfma_f32_16x16x32_bf16 v[36:39], v[128:131], v[140:143], v[36:39]
    ds_read_b128 v[112:115], v45 offset:6912
    v_mfma_f32_16x16x32_bf16 v[32:35], v[116:119], v[124:127], v[32:35]
    ds_read_b64_tr_b16 v[124:125], v47 offset:0
    s_waitcnt lgkmcnt(7)
    v_mfma_f32_16x16x32_bf16 v[32:35], v[128:131], v[100:103], v[32:35]
    ds_read_b64_tr_b16 v[126:127], v47 offset:256
    v_mfma_f32_16x16x32_bf16 v[28:31], v[116:119], v[140:143], v[28:31]
    ds_read_b64_tr_b16 v[132:133], v47 offset:2048
    s_waitcnt lgkmcnt(8)
    v_mfma_f32_16x16x32_bf16 v[28:31], v[128:131], v[104:107], v[28:31]
    ds_read_b64_tr_b16 v[134:135], v47 offset:2304
    v_mfma_f32_16x16x32_bf16 v[24:27], v[116:119], v[100:103], v[24:27]
    s_waitcnt lgkmcnt(8)
    v_mfma_f32_16x16x32_bf16 v[24:27], v[128:131], v[120:123], v[24:27]
    v_mfma_f32_16x16x32_bf16 v[20:23], v[116:119], v[104:107], v[20:23]
    s_waitcnt lgkmcnt(7)
    v_mfma_f32_16x16x32_bf16 v[20:23], v[128:131], v[96:99], v[20:23]
    v_mfma_f32_16x16x32_bf16 v[16:19], v[116:119], v[120:123], v[16:19]
    s_waitcnt lgkmcnt(6)
    v_mfma_f32_16x16x32_bf16 v[16:19], v[128:131], v[108:111], v[16:19]
    v_mfma_f32_16x16x32_bf16 v[12:15], v[116:119], v[96:99], v[12:15]
    s_waitcnt lgkmcnt(5)
    v_mfma_f32_16x16x32_bf16 v[12:15], v[128:131], v[92:95], v[12:15]
    v_mfma_f32_16x16x32_bf16 v[8:11], v[116:119], v[108:111], v[8:11]
    s_waitcnt lgkmcnt(4)
    v_mfma_f32_16x16x32_bf16 v[8:11], v[128:131], v[112:115], v[8:11]
    ds_read_b128 v[116:119], v45 offset:6336
    s_waitcnt lgkmcnt(3)
    v_mfma_f32_16x16x32_bf16 v[40:43], v[124:127], v[100:103], v[40:43]
    s_waitcnt lgkmcnt(1)
    v_mfma_f32_16x16x32_bf16 v[40:43], v[132:135], v[120:123], v[40:43]
    ds_read_b128 v[100:103], v45 offset:5760
    v_mfma_f32_16x16x32_bf16 v[36:39], v[124:127], v[104:107], v[36:39]
    ds_read_b128 v[104:107], v45 offset:5184
    v_mfma_f32_16x16x32_bf16 v[36:39], v[132:135], v[96:99], v[36:39]
    ds_read_b128 v[128:131], v45 offset:4608
    v_mfma_f32_16x16x32_bf16 v[32:35], v[124:127], v[120:123], v[32:35]
    ds_read_b64_tr_b16 v[120:121], v47 offset:4096
    v_mfma_f32_16x16x32_bf16 v[32:35], v[132:135], v[108:111], v[32:35]
    ds_read_b64_tr_b16 v[122:123], v47 offset:4352
    v_mfma_f32_16x16x32_bf16 v[28:31], v[124:127], v[96:99], v[28:31]
    ds_read_b64_tr_b16 v[96:97], v47 offset:6144
    v_mfma_f32_16x16x32_bf16 v[28:31], v[132:135], v[92:95], v[28:31]
    ds_read_b64_tr_b16 v[98:99], v47 offset:6400
    v_mfma_f32_16x16x32_bf16 v[24:27], v[124:127], v[108:111], v[24:27]
    v_mfma_f32_16x16x32_bf16 v[24:27], v[132:135], v[112:115], v[24:27]
    v_mfma_f32_16x16x32_bf16 v[20:23], v[124:127], v[92:95], v[20:23]
    s_waitcnt lgkmcnt(7)
    v_mfma_f32_16x16x32_bf16 v[20:23], v[132:135], v[116:119], v[20:23]
    v_mfma_f32_16x16x32_bf16 v[16:19], v[124:127], v[112:115], v[16:19]
    s_waitcnt lgkmcnt(6)
    v_mfma_f32_16x16x32_bf16 v[16:19], v[132:135], v[100:103], v[16:19]
    v_mfma_f32_16x16x32_bf16 v[12:15], v[124:127], v[116:119], v[12:15]
    s_waitcnt lgkmcnt(5)
    v_mfma_f32_16x16x32_bf16 v[12:15], v[132:135], v[104:107], v[12:15]
    v_mfma_f32_16x16x32_bf16 v[8:11], v[124:127], v[100:103], v[8:11]
    s_waitcnt lgkmcnt(4)
    v_mfma_f32_16x16x32_bf16 v[8:11], v[132:135], v[128:131], v[8:11]
    ds_read_b128 v[124:127], v45 offset:4032
    s_waitcnt lgkmcnt(3)
    v_mfma_f32_16x16x32_bf16 v[40:43], v[120:123], v[108:111], v[40:43]
    s_waitcnt lgkmcnt(1)
    v_mfma_f32_16x16x32_bf16 v[40:43], v[96:99], v[112:115], v[40:43]
    ds_read_b128 v[108:111], v45 offset:3456
    v_mfma_f32_16x16x32_bf16 v[36:39], v[120:123], v[92:95], v[36:39]
    ds_read_b128 v[92:95], v45 offset:2880
    v_mfma_f32_16x16x32_bf16 v[36:39], v[96:99], v[116:119], v[36:39]
    ds_read_b128 v[132:135], v45 offset:2304
    v_mfma_f32_16x16x32_bf16 v[32:35], v[120:123], v[112:115], v[32:35]
    ds_read_b64_tr_b16 v[112:113], v47 offset:8192
    v_mfma_f32_16x16x32_bf16 v[32:35], v[96:99], v[100:103], v[32:35]
    ds_read_b64_tr_b16 v[114:115], v47 offset:8448
    v_mfma_f32_16x16x32_bf16 v[28:31], v[120:123], v[116:119], v[28:31]
    ds_read_b64_tr_b16 v[116:117], v47 offset:10240
    v_mfma_f32_16x16x32_bf16 v[28:31], v[96:99], v[104:107], v[28:31]
    ds_read_b64_tr_b16 v[118:119], v47 offset:10496
    v_mfma_f32_16x16x32_bf16 v[24:27], v[120:123], v[100:103], v[24:27]
    v_mfma_f32_16x16x32_bf16 v[24:27], v[96:99], v[128:131], v[24:27]
    v_mfma_f32_16x16x32_bf16 v[20:23], v[120:123], v[104:107], v[20:23]
    s_waitcnt lgkmcnt(7)
    v_mfma_f32_16x16x32_bf16 v[20:23], v[96:99], v[124:127], v[20:23]
    v_mfma_f32_16x16x32_bf16 v[16:19], v[120:123], v[128:131], v[16:19]
    s_waitcnt lgkmcnt(6)
    v_mfma_f32_16x16x32_bf16 v[16:19], v[96:99], v[108:111], v[16:19]
    v_mfma_f32_16x16x32_bf16 v[12:15], v[120:123], v[124:127], v[12:15]
    s_waitcnt lgkmcnt(5)
    v_mfma_f32_16x16x32_bf16 v[12:15], v[96:99], v[92:95], v[12:15]
    v_mfma_f32_16x16x32_bf16 v[8:11], v[120:123], v[108:111], v[8:11]
    ds_read_b128 v[120:123], v45 offset:1728
    s_waitcnt lgkmcnt(5)
    v_mfma_f32_16x16x32_bf16 v[8:11], v[96:99], v[132:135], v[8:11]
    ds_read_b128 v[96:99], v45 offset:1152
    s_waitcnt lgkmcnt(4)
    v_mfma_f32_16x16x32_bf16 v[40:43], v[112:115], v[100:103], v[40:43]
    ds_read_b128 v[100:103], v45 offset:576
    s_waitcnt lgkmcnt(3)
    v_mfma_f32_16x16x32_bf16 v[40:43], v[116:119], v[128:131], v[40:43]
    ds_read_b128 v[136:139], v46 offset:0
    s_barrier
    v_mfma_f32_16x16x32_bf16 v[36:39], v[112:115], v[104:107], v[36:39]
    ds_read_b128 v[104:107], v82 offset:12800
    v_mfma_f32_16x16x32_bf16 v[36:39], v[116:119], v[124:127], v[36:39]
    ds_read_b64_tr_b16 v[140:141], v47 offset:12288
    v_mfma_f32_16x16x32_bf16 v[32:35], v[112:115], v[128:131], v[32:35]
    ds_read_b64_tr_b16 v[142:143], v47 offset:12544
    v_mfma_f32_16x16x32_bf16 v[32:35], v[116:119], v[108:111], v[32:35]
    ds_read_b128 v[128:131], v81 offset:12224
    v_mfma_f32_16x16x32_bf16 v[28:31], v[112:115], v[124:127], v[28:31]
    ds_read_b64_tr_b16 v[124:125], v47 offset:14336
    v_mfma_f32_16x16x32_bf16 v[28:31], v[116:119], v[92:95], v[28:31]
    ds_read_b64_tr_b16 v[126:127], v47 offset:14592
    v_mfma_f32_16x16x32_bf16 v[24:27], v[112:115], v[108:111], v[24:27]
    v_mfma_f32_16x16x32_bf16 v[24:27], v[116:119], v[132:135], v[24:27]
    ds_read_b128 v[108:111], v80 offset:11648
    v_mfma_f32_16x16x32_bf16 v[20:23], v[112:115], v[92:95], v[20:23]
    s_waitcnt lgkmcnt(10)
    v_mfma_f32_16x16x32_bf16 v[20:23], v[116:119], v[120:123], v[20:23]
    ds_read_b128 v[92:95], v79 offset:11072
    v_mfma_f32_16x16x32_bf16 v[16:19], v[112:115], v[132:135], v[16:19]
    s_waitcnt lgkmcnt(10)
    v_mfma_f32_16x16x32_bf16 v[16:19], v[116:119], v[96:99], v[16:19]
    ds_read_b128 v[132:135], v78 offset:10496
    v_mfma_f32_16x16x32_bf16 v[12:15], v[112:115], v[120:123], v[12:15]
    s_waitcnt lgkmcnt(10)
    v_mfma_f32_16x16x32_bf16 v[12:15], v[116:119], v[100:103], v[12:15]
    ds_read_b128 v[100:103], v77 offset:9920
    v_mfma_f32_16x16x32_bf16 v[8:11], v[112:115], v[96:99], v[8:11]
    s_waitcnt lgkmcnt(10)
    v_mfma_f32_16x16x32_bf16 v[8:11], v[116:119], v[136:139], v[8:11]
    ds_read_b128 v[96:99], v76 offset:9344
    s_waitcnt lgkmcnt(8)
    v_mfma_f32_16x16x32_bf16 v[40:43], v[140:143], v[104:107], v[40:43]
    s_waitcnt lgkmcnt(5)
    v_mfma_f32_16x16x32_bf16 v[40:43], v[124:127], v[128:131], v[40:43]
    ds_read_b128 v[104:107], v83 offset:8768
    v_mfma_f32_16x16x32_bf16 v[36:39], v[140:143], v[128:131], v[36:39]
    ds_read_b128 v[112:115], v82 offset:8192
    s_waitcnt lgkmcnt(6)
    v_mfma_f32_16x16x32_bf16 v[36:39], v[124:127], v[108:111], v[36:39]
    ds_read_b128 v[116:119], v81 offset:7616
    v_mfma_f32_16x16x32_bf16 v[32:35], v[140:143], v[108:111], v[32:35]
    ds_read_b64_tr_b16 v[120:121], v47 offset:16384
    s_waitcnt lgkmcnt(7)
    v_mfma_f32_16x16x32_bf16 v[32:35], v[124:127], v[92:95], v[32:35]
    ds_read_b64_tr_b16 v[122:123], v47 offset:16640
    v_mfma_f32_16x16x32_bf16 v[28:31], v[140:143], v[92:95], v[28:31]
    ds_read_b64_tr_b16 v[128:129], v47 offset:18432
    s_waitcnt lgkmcnt(8)
    v_mfma_f32_16x16x32_bf16 v[28:31], v[124:127], v[132:135], v[28:31]
    ds_read_b64_tr_b16 v[130:131], v47 offset:18688
    v_mfma_f32_16x16x32_bf16 v[24:27], v[140:143], v[132:135], v[24:27]
    s_waitcnt lgkmcnt(8)
    v_mfma_f32_16x16x32_bf16 v[24:27], v[124:127], v[100:103], v[24:27]
    v_mfma_f32_16x16x32_bf16 v[20:23], v[140:143], v[100:103], v[20:23]
    s_waitcnt lgkmcnt(7)
    v_mfma_f32_16x16x32_bf16 v[20:23], v[124:127], v[96:99], v[20:23]
    v_mfma_f32_16x16x32_bf16 v[16:19], v[140:143], v[96:99], v[16:19]
    s_waitcnt lgkmcnt(6)
    v_mfma_f32_16x16x32_bf16 v[16:19], v[124:127], v[104:107], v[16:19]
    v_mfma_f32_16x16x32_bf16 v[12:15], v[140:143], v[104:107], v[12:15]
    s_waitcnt lgkmcnt(5)
    v_mfma_f32_16x16x32_bf16 v[12:15], v[124:127], v[112:115], v[12:15]
    v_mfma_f32_16x16x32_bf16 v[8:11], v[140:143], v[112:115], v[8:11]
    s_waitcnt lgkmcnt(4)
    v_mfma_f32_16x16x32_bf16 v[8:11], v[124:127], v[116:119], v[8:11]
    s_waitcnt lgkmcnt(2)
    v_mfma_f32_16x16x32_bf16 v[40:43], v[120:123], v[108:111], v[40:43]
    s_waitcnt lgkmcnt(0)
    v_mfma_f32_16x16x32_bf16 v[40:43], v[128:131], v[92:95], v[40:43]
    v_mfma_f32_16x16x32_bf16 v[36:39], v[120:123], v[92:95], v[36:39]
    ds_read_b128 v[92:95], v80 offset:7040
    v_mfma_f32_16x16x32_bf16 v[36:39], v[128:131], v[132:135], v[36:39]
    ds_read_b128 v[108:111], v79 offset:6464
    v_mfma_f32_16x16x32_bf16 v[32:35], v[120:123], v[132:135], v[32:35]
    ds_read_b64_tr_b16 v[124:125], v47 offset:20480
    v_mfma_f32_16x16x32_bf16 v[32:35], v[128:131], v[100:103], v[32:35]
    ds_read_b64_tr_b16 v[126:127], v47 offset:20736
    v_mfma_f32_16x16x32_bf16 v[28:31], v[120:123], v[100:103], v[28:31]
    ds_read_b64_tr_b16 v[136:137], v47 offset:22528
    v_mfma_f32_16x16x32_bf16 v[28:31], v[128:131], v[96:99], v[28:31]
    ds_read_b64_tr_b16 v[138:139], v47 offset:22784
    v_mfma_f32_16x16x32_bf16 v[24:27], v[120:123], v[96:99], v[24:27]
    v_mfma_f32_16x16x32_bf16 v[24:27], v[128:131], v[104:107], v[24:27]
    v_mfma_f32_16x16x32_bf16 v[20:23], v[120:123], v[104:107], v[20:23]
    v_mfma_f32_16x16x32_bf16 v[20:23], v[128:131], v[112:115], v[20:23]
    v_mfma_f32_16x16x32_bf16 v[16:19], v[120:123], v[112:115], v[16:19]
    v_mfma_f32_16x16x32_bf16 v[16:19], v[128:131], v[116:119], v[16:19]
    v_mfma_f32_16x16x32_bf16 v[12:15], v[120:123], v[116:119], v[12:15]
    s_waitcnt lgkmcnt(5)
    v_mfma_f32_16x16x32_bf16 v[12:15], v[128:131], v[92:95], v[12:15]
    v_mfma_f32_16x16x32_bf16 v[8:11], v[120:123], v[92:95], v[8:11]
    s_waitcnt lgkmcnt(4)
    v_mfma_f32_16x16x32_bf16 v[8:11], v[128:131], v[108:111], v[8:11]
    s_waitcnt lgkmcnt(2)
    v_mfma_f32_16x16x32_bf16 v[40:43], v[124:127], v[132:135], v[40:43]
    s_waitcnt lgkmcnt(0)
    v_mfma_f32_16x16x32_bf16 v[40:43], v[136:139], v[100:103], v[40:43]
    s_barrier
    v_mfma_f32_16x16x32_bf16 v[36:39], v[124:127], v[100:103], v[36:39]
    ds_read_b128 v[100:103], v78 offset:5888
    v_mfma_f32_16x16x32_bf16 v[36:39], v[136:139], v[96:99], v[36:39]
    ds_read_b128 v[120:123], v77 offset:5312
    v_mfma_f32_16x16x32_bf16 v[32:35], v[124:127], v[96:99], v[32:35]
    ds_read_b64_tr_b16 v[128:129], v47 offset:24576
    v_mfma_f32_16x16x32_bf16 v[32:35], v[136:139], v[104:107], v[32:35]
    ds_read_b64_tr_b16 v[130:131], v47 offset:24832
    v_mfma_f32_16x16x32_bf16 v[28:31], v[124:127], v[104:107], v[28:31]
    ds_read_b64_tr_b16 v[132:133], v47 offset:26624
    v_mfma_f32_16x16x32_bf16 v[28:31], v[136:139], v[112:115], v[28:31]
    ds_read_b64_tr_b16 v[134:135], v47 offset:26880
    v_mfma_f32_16x16x32_bf16 v[24:27], v[124:127], v[112:115], v[24:27]
    v_mfma_f32_16x16x32_bf16 v[24:27], v[136:139], v[116:119], v[24:27]
    v_mfma_f32_16x16x32_bf16 v[20:23], v[124:127], v[116:119], v[20:23]
    v_mfma_f32_16x16x32_bf16 v[20:23], v[136:139], v[92:95], v[20:23]
    v_mfma_f32_16x16x32_bf16 v[16:19], v[124:127], v[92:95], v[16:19]
    v_mfma_f32_16x16x32_bf16 v[16:19], v[136:139], v[108:111], v[16:19]
    v_mfma_f32_16x16x32_bf16 v[12:15], v[124:127], v[108:111], v[12:15]
    s_waitcnt lgkmcnt(5)
    v_mfma_f32_16x16x32_bf16 v[12:15], v[136:139], v[100:103], v[12:15]
    v_mfma_f32_16x16x32_bf16 v[8:11], v[124:127], v[100:103], v[8:11]
    s_waitcnt lgkmcnt(4)
    v_mfma_f32_16x16x32_bf16 v[8:11], v[136:139], v[120:123], v[8:11]
    s_waitcnt lgkmcnt(2)
    v_mfma_f32_16x16x32_bf16 v[40:43], v[128:131], v[96:99], v[40:43]
    s_waitcnt lgkmcnt(0)
    v_mfma_f32_16x16x32_bf16 v[40:43], v[132:135], v[104:107], v[40:43]
    v_mfma_f32_16x16x32_bf16 v[36:39], v[128:131], v[104:107], v[36:39]
    ds_read_b128 v[96:99], v76 offset:4736
    v_mfma_f32_16x16x32_bf16 v[36:39], v[132:135], v[112:115], v[36:39]
    ds_read_b128 v[104:107], v83 offset:4160
    v_mfma_f32_16x16x32_bf16 v[32:35], v[128:131], v[112:115], v[32:35]
    ds_read_b64_tr_b16 v[124:125], v47 offset:28672
    v_mfma_f32_16x16x32_bf16 v[32:35], v[132:135], v[116:119], v[32:35]
    ds_read_b64_tr_b16 v[126:127], v47 offset:28928
    v_mfma_f32_16x16x32_bf16 v[28:31], v[128:131], v[116:119], v[28:31]
    ds_read_b64_tr_b16 v[136:137], v47 offset:30720
    v_mfma_f32_16x16x32_bf16 v[28:31], v[132:135], v[92:95], v[28:31]
    ds_read_b64_tr_b16 v[138:139], v47 offset:30976
    v_mfma_f32_16x16x32_bf16 v[24:27], v[128:131], v[92:95], v[24:27]
    v_mfma_f32_16x16x32_bf16 v[24:27], v[132:135], v[108:111], v[24:27]
    v_mfma_f32_16x16x32_bf16 v[20:23], v[128:131], v[108:111], v[20:23]
    v_mfma_f32_16x16x32_bf16 v[20:23], v[132:135], v[100:103], v[20:23]
    v_mfma_f32_16x16x32_bf16 v[16:19], v[128:131], v[100:103], v[16:19]
    v_mfma_f32_16x16x32_bf16 v[16:19], v[132:135], v[120:123], v[16:19]
    v_mfma_f32_16x16x32_bf16 v[12:15], v[128:131], v[120:123], v[12:15]
    s_waitcnt lgkmcnt(5)
    v_mfma_f32_16x16x32_bf16 v[12:15], v[132:135], v[96:99], v[12:15]
    v_mfma_f32_16x16x32_bf16 v[8:11], v[128:131], v[96:99], v[8:11]
    s_waitcnt lgkmcnt(4)
    v_mfma_f32_16x16x32_bf16 v[8:11], v[132:135], v[104:107], v[8:11]
    s_waitcnt lgkmcnt(2)
    v_mfma_f32_16x16x32_bf16 v[40:43], v[124:127], v[112:115], v[40:43]
    s_waitcnt lgkmcnt(0)
    v_mfma_f32_16x16x32_bf16 v[40:43], v[136:139], v[116:119], v[40:43]
    v_mfma_f32_16x16x32_bf16 v[36:39], v[124:127], v[116:119], v[36:39]
    ds_read_b128 v[112:115], v82 offset:3584
    v_mfma_f32_16x16x32_bf16 v[36:39], v[136:139], v[92:95], v[36:39]
    ds_read_b128 v[116:119], v81 offset:3008
    v_mfma_f32_16x16x32_bf16 v[32:35], v[124:127], v[92:95], v[32:35]
    ds_read_b64_tr_b16 v[128:129], v47 offset:32768
    v_mfma_f32_16x16x32_bf16 v[32:35], v[136:139], v[108:111], v[32:35]
    ds_read_b64_tr_b16 v[130:131], v47 offset:33024
    v_mfma_f32_16x16x32_bf16 v[28:31], v[124:127], v[108:111], v[28:31]
    ds_read_b64_tr_b16 v[132:133], v47 offset:34816
    v_mfma_f32_16x16x32_bf16 v[28:31], v[136:139], v[100:103], v[28:31]
    ds_read_b64_tr_b16 v[134:135], v47 offset:35072
    v_mfma_f32_16x16x32_bf16 v[24:27], v[124:127], v[100:103], v[24:27]
    v_mfma_f32_16x16x32_bf16 v[24:27], v[136:139], v[120:123], v[24:27]
    v_mfma_f32_16x16x32_bf16 v[20:23], v[124:127], v[120:123], v[20:23]
    v_mfma_f32_16x16x32_bf16 v[20:23], v[136:139], v[96:99], v[20:23]
    v_mfma_f32_16x16x32_bf16 v[16:19], v[124:127], v[96:99], v[16:19]
    v_mfma_f32_16x16x32_bf16 v[16:19], v[136:139], v[104:107], v[16:19]
    ds_read_b128 v[140:143], v80 offset:2432
    v_mfma_f32_16x16x32_bf16 v[12:15], v[124:127], v[104:107], v[12:15]
    ds_read_b128 v[144:147], v79 offset:1856
    s_waitcnt lgkmcnt(7)
    v_mfma_f32_16x16x32_bf16 v[12:15], v[136:139], v[112:115], v[12:15]
    ds_read_b64_tr_b16 v[148:149], v47 offset:36864
    v_mfma_f32_16x16x32_bf16 v[8:11], v[124:127], v[112:115], v[8:11]
    ds_read_b64_tr_b16 v[150:151], v47 offset:37120
    s_waitcnt lgkmcnt(8)
    v_mfma_f32_16x16x32_bf16 v[8:11], v[136:139], v[116:119], v[8:11]
    ds_read_b64_tr_b16 v[124:125], v47 offset:38912
    s_waitcnt lgkmcnt(7)
    v_mfma_f32_16x16x32_bf16 v[40:43], v[128:131], v[92:95], v[40:43]
    ds_read_b64_tr_b16 v[126:127], v47 offset:39168
    s_waitcnt lgkmcnt(6)
    v_mfma_f32_16x16x32_bf16 v[40:43], v[132:135], v[108:111], v[40:43]
    ds_read_b128 v[92:95], v78 offset:1280
    s_barrier
    v_mfma_f32_16x16x32_bf16 v[36:39], v[128:131], v[108:111], v[36:39]
    ds_read_b128 v[108:111], v77 offset:704
    v_mfma_f32_16x16x32_bf16 v[36:39], v[132:135], v[100:103], v[36:39]
    ds_read_b64_tr_b16 v[136:137], v47 offset:40960
    v_mfma_f32_16x16x32_bf16 v[32:35], v[128:131], v[100:103], v[32:35]
    ds_read_b64_tr_b16 v[138:139], v47 offset:41216
    v_mfma_f32_16x16x32_bf16 v[32:35], v[132:135], v[120:123], v[32:35]
    ds_read_b128 v[152:155], v76 offset:128
    v_mfma_f32_16x16x32_bf16 v[28:31], v[128:131], v[120:123], v[28:31]
    ds_read_b128 v[156:159], v82 offset:12864
    v_mfma_f32_16x16x32_bf16 v[28:31], v[132:135], v[96:99], v[28:31]
    ds_read_b64_tr_b16 v[160:161], v47 offset:43008
    v_mfma_f32_16x16x32_bf16 v[24:27], v[128:131], v[96:99], v[24:27]
    ds_read_b64_tr_b16 v[162:163], v47 offset:43264
    v_mfma_f32_16x16x32_bf16 v[24:27], v[132:135], v[104:107], v[24:27]
    ds_read_b128 v[164:167], v81 offset:12288
    v_mfma_f32_16x16x32_bf16 v[20:23], v[128:131], v[104:107], v[20:23]
    ds_read_b64_tr_b16 v[168:169], v47 offset:45056
    v_mfma_f32_16x16x32_bf16 v[20:23], v[132:135], v[112:115], v[20:23]
    ds_read_b64_tr_b16 v[170:171], v47 offset:45312
    v_mfma_f32_16x16x32_bf16 v[16:19], v[128:131], v[112:115], v[16:19]
    ds_read_b128 v[172:175], v80 offset:11712
    v_mfma_f32_16x16x32_bf16 v[16:19], v[132:135], v[116:119], v[16:19]
    ds_read_b64_tr_b16 v[176:177], v47 offset:47104
    v_mfma_f32_16x16x32_bf16 v[12:15], v[128:131], v[116:119], v[12:15]
    ds_read_b64_tr_b16 v[178:179], v47 offset:47360
    s_waitcnt lgkmcnt(15)
    v_mfma_f32_16x16x32_bf16 v[12:15], v[132:135], v[140:143], v[12:15]
    ds_read_b128 v[180:183], v79 offset:11136
    v_mfma_f32_16x16x32_bf16 v[8:11], v[128:131], v[140:143], v[8:11]
    ds_read_b64_tr_b16 v[128:129], v47 offset:49152
    v_mfma_f32_16x16x32_bf16 v[8:11], v[132:135], v[144:147], v[8:11]
    ds_read_b64_tr_b16 v[130:131], v47 offset:49408
    v_mfma_f32_16x16x32_bf16 v[40:43], v[148:151], v[100:103], v[40:43]
    ds_read_b128 v[100:103], v78 offset:10560
    s_waitcnt lgkmcnt(15)
    v_mfma_f32_16x16x32_bf16 v[40:43], v[124:127], v[120:123], v[40:43]
    ds_read_b64_tr_b16 v[132:133], v47 offset:51200
    v_mfma_f32_16x16x32_bf16 v[36:39], v[148:151], v[120:123], v[36:39]
    ds_read_b64_tr_b16 v[134:135], v47 offset:51456
    v_mfma_f32_16x16x32_bf16 v[36:39], v[124:127], v[96:99], v[36:39]
    ds_read_b128 v[120:123], v77 offset:9984
    v_mfma_f32_16x16x32_bf16 v[32:35], v[148:151], v[96:99], v[32:35]
    ds_read_b64_tr_b16 v[184:185], v47 offset:53248
    v_mfma_f32_16x16x32_bf16 v[32:35], v[124:127], v[104:107], v[32:35]
    ds_read_b64_tr_b16 v[186:187], v47 offset:53504
    v_mfma_f32_16x16x32_bf16 v[28:31], v[148:151], v[104:107], v[28:31]
    ds_read_b128 v[188:191], v76 offset:9408
    v_mfma_f32_16x16x32_bf16 v[28:31], v[124:127], v[112:115], v[28:31]
    ds_read_b64_tr_b16 v[192:193], v47 offset:55296
    v_mfma_f32_16x16x32_bf16 v[24:27], v[148:151], v[112:115], v[24:27]
    ds_read_b64_tr_b16 v[194:195], v47 offset:55552
    v_mfma_f32_16x16x32_bf16 v[24:27], v[124:127], v[116:119], v[24:27]
    ds_read_b128 v[196:199], v83 offset:8832
    v_mfma_f32_16x16x32_bf16 v[20:23], v[148:151], v[116:119], v[20:23]
    ds_read_b64_tr_b16 v[200:201], v47 offset:57344
    v_mfma_f32_16x16x32_bf16 v[20:23], v[124:127], v[140:143], v[20:23]
    ds_read_b64_tr_b16 v[202:203], v47 offset:57600
    v_mfma_f32_16x16x32_bf16 v[16:19], v[148:151], v[140:143], v[16:19]
    ds_read_b128 v[204:207], v82 offset:8256
    v_mfma_f32_16x16x32_bf16 v[16:19], v[124:127], v[144:147], v[16:19]
    ds_read_b64_tr_b16 v[208:209], v47 offset:59392
    v_mfma_f32_16x16x32_bf16 v[12:15], v[148:151], v[144:147], v[12:15]
    ds_read_b64_tr_b16 v[210:211], v47 offset:59648
    v_mfma_f32_16x16x32_bf16 v[12:15], v[124:127], v[92:95], v[12:15]
    ds_read_b128 v[212:215], v81 offset:7680
    v_mfma_f32_16x16x32_bf16 v[8:11], v[148:151], v[92:95], v[8:11]
    ds_read_b64_tr_b16 v[148:149], v47 offset:61440
    v_mfma_f32_16x16x32_bf16 v[8:11], v[124:127], v[108:111], v[8:11]
    ds_read_b64_tr_b16 v[150:151], v47 offset:61696
    s_waitcnt lgkmcnt(15)
    v_mfma_f32_16x16x32_bf16 v[40:43], v[136:139], v[96:99], v[40:43]
    ds_read_b128 v[96:99], v80 offset:7104
    v_mfma_f32_16x16x32_bf16 v[36:39], v[136:139], v[104:107], v[36:39]
    ds_read_b64_tr_b16 v[104:105], v47 offset:63488
    s_barrier
    v_mfma_f32_16x16x32_bf16 v[32:35], v[136:139], v[112:115], v[32:35]
    ds_read_b64_tr_b16 v[106:107], v47 offset:63744
    v_mfma_f32_16x16x32_bf16 v[28:31], v[136:139], v[116:119], v[28:31]
    ds_read_b128 v[112:115], v79 offset:6528
    v_mfma_f32_16x16x32_bf16 v[24:27], v[136:139], v[140:143], v[24:27]
    ds_read_b64_tr_b16 v[116:117], v47 offset:0
    v_mfma_f32_16x16x32_bf16 v[20:23], v[136:139], v[144:147], v[20:23]
    ds_read_b64_tr_b16 v[118:119], v47 offset:256
    v_mfma_f32_16x16x32_bf16 v[16:19], v[136:139], v[92:95], v[16:19]
    ds_read_b128 v[92:95], v78 offset:5952
    v_mfma_f32_16x16x32_bf16 v[12:15], v[136:139], v[108:111], v[12:15]
    ds_read_b64_tr_b16 v[108:109], v47 offset:2048
    v_mfma_f32_16x16x32_bf16 v[8:11], v[136:139], v[152:155], v[8:11]
    ds_read_b64_tr_b16 v[110:111], v47 offset:2304
    v_mfma_f32_16x16x32_bf16 v[40:43], v[160:163], v[156:159], v[40:43]
    ds_read_b128 v[136:139], v77 offset:5376
    ds_read_b64_tr_b16 v[124:125], v47 offset:4096
    v_mfma_f32_16x16x32_bf16 v[40:43], v[168:171], v[164:167], v[40:43]
    ds_read_b64_tr_b16 v[126:127], v47 offset:4352
    ds_read_b128 v[140:143], v76 offset:4800
    v_mfma_f32_16x16x32_bf16 v[40:43], v[176:179], v[172:175], v[40:43]
    ds_read_b64_tr_b16 v[144:145], v47 offset:6144
    ds_read_b64_tr_b16 v[146:147], v47 offset:6400
    v_mfma_f32_16x16x32_bf16 v[40:43], v[128:131], v[180:183], v[40:43]
    v_mfma_f32_16x16x32_bf16 v[40:43], v[132:135], v[100:103], v[40:43]
    s_waitcnt lgkmcnt(15)
    v_mfma_f32_16x16x32_bf16 v[40:43], v[184:187], v[120:123], v[40:43]
    v_mfma_f32_16x16x32_bf16 v[40:43], v[192:195], v[188:191], v[40:43]
    v_mfma_f32_16x16x32_bf16 v[40:43], v[200:203], v[196:199], v[40:43]
    v_mfma_f32_16x16x32_bf16 v[40:43], v[208:211], v[204:207], v[40:43]
    v_mfma_f32_16x16x32_bf16 v[40:43], v[148:151], v[212:215], v[40:43]
    s_waitcnt lgkmcnt(12)
    v_mfma_f32_16x16x32_bf16 v[40:43], v[104:107], v[96:99], v[40:43]
    s_waitcnt lgkmcnt(9)
    v_mfma_f32_16x16x32_bf16 v[40:43], v[116:119], v[112:115], v[40:43]
    ds_read_b128 v[152:155], v83 offset:4224
    ds_read_b128 v[156:159], v82 offset:3648
    s_waitcnt lgkmcnt(8)
    v_mfma_f32_16x16x32_bf16 v[40:43], v[108:111], v[92:95], v[40:43]
    ds_read_b128 v[216:219], v81 offset:3072
    ds_read_b128 v[220:223], v80 offset:2496
    s_waitcnt lgkmcnt(7)
    v_mfma_f32_16x16x32_bf16 v[40:43], v[124:127], v[136:139], v[40:43]
    ds_read_b128 v[224:227], v79 offset:1920
    ds_read_b128 v[228:231], v78 offset:1344
    s_waitcnt lgkmcnt(6)
    v_mfma_f32_16x16x32_bf16 v[40:43], v[144:147], v[140:143], v[40:43]
    ds_read_b128 v[232:235], v77 offset:768
    ds_read_b128 v[236:239], v76 offset:192
    v_mfma_f32_16x16x32_bf16 v[36:39], v[160:163], v[164:167], v[36:39]
    s_nop 1
    v_mfma_f32_16x16x32_bf16 v[36:39], v[168:171], v[172:175], v[36:39]
    s_nop 1
    v_mfma_f32_16x16x32_bf16 v[36:39], v[176:179], v[180:183], v[36:39]
    v_mul_f32 v40, s56, v40
    v_mul_f32 v41, s56, v41
    v_mfma_f32_16x16x32_bf16 v[36:39], v[128:131], v[100:103], v[36:39]
    v_mul_f32 v42, s56, v42
    v_mul_f32 v43, s56, v43
    v_mfma_f32_16x16x32_bf16 v[36:39], v[132:135], v[120:123], v[36:39]
    v_exp_f32 v40, v40
    v_mfma_f32_16x16x32_bf16 v[36:39], v[184:187], v[188:191], v[36:39]
    v_exp_f32 v41, v41
    v_mfma_f32_16x16x32_bf16 v[36:39], v[192:195], v[196:199], v[36:39]
    v_exp_f32 v42, v42
    v_mfma_f32_16x16x32_bf16 v[36:39], v[200:203], v[204:207], v[36:39]
    v_exp_f32 v43, v43
    v_mfma_f32_16x16x32_bf16 v[36:39], v[208:211], v[212:215], v[36:39]
    v_add_f32 v40, 1.0, v40
    v_add_f32 v41, 1.0, v41
    v_mfma_f32_16x16x32_bf16 v[36:39], v[148:151], v[96:99], v[36:39]
    v_add_f32 v42, 1.0, v42
    v_add_f32 v43, 1.0, v43
    v_mfma_f32_16x16x32_bf16 v[36:39], v[104:107], v[112:115], v[36:39]
    v_rcp_f32 v40, v40
    v_mfma_f32_16x16x32_bf16 v[36:39], v[116:119], v[92:95], v[36:39]
    v_rcp_f32 v41, v41
    v_mfma_f32_16x16x32_bf16 v[36:39], v[108:111], v[136:139], v[36:39]
    v_rcp_f32 v42, v42
    v_mfma_f32_16x16x32_bf16 v[36:39], v[124:127], v[140:143], v[36:39]
    v_rcp_f32 v43, v43
    s_waitcnt lgkmcnt(7)
    v_mfma_f32_16x16x32_bf16 v[36:39], v[144:147], v[152:155], v[36:39]
    v_fma_f32 v40, v40, v49, v50
    v_fma_f32 v41, v41, v49, v50
    s_barrier
    v_mfma_f32_16x16x32_bf16 v[32:35], v[160:163], v[172:175], v[32:35]
    v_fma_f32 v42, v42, v49, v50
    v_fma_f32 v43, v43, v49, v50
    v_mfma_f32_16x16x32_bf16 v[32:35], v[168:171], v[180:183], v[32:35]
    v_cvt_pk_f16_f32 v60, v40, v41
    v_cvt_pk_f16_f32 v61, v42, v43
    v_mfma_f32_16x16x32_bf16 v[32:35], v[176:179], v[100:103], v[32:35]
    v_mov_b32 v62, v60
    v_mov_b32 v63, v61
    v_mfma_f32_16x16x32_bf16 v[32:35], v[128:131], v[120:123], v[32:35]
    v_mul_f32 v36, s56, v36
    v_permlane32_swap_b32 v60, v62
    v_mfma_f32_16x16x32_bf16 v[32:35], v[132:135], v[188:191], v[32:35]
    v_permlane32_swap_b32 v61, v63
    buffer_store_dwordx4 v[60:63], v7, s[20:23], s76 offen sc1
    v_mfma_f32_16x16x32_bf16 v[32:35], v[184:187], v[196:199], v[32:35]
    v_mul_f32 v37, s56, v37
    v_mul_f32 v38, s56, v38
    v_mfma_f32_16x16x32_bf16 v[32:35], v[192:195], v[204:207], v[32:35]
    v_mul_f32 v39, s56, v39
    v_mfma_f32_16x16x32_bf16 v[32:35], v[200:203], v[212:215], v[32:35]
    v_exp_f32 v36, v36
    v_mfma_f32_16x16x32_bf16 v[32:35], v[208:211], v[96:99], v[32:35]
    v_exp_f32 v37, v37
    v_mfma_f32_16x16x32_bf16 v[32:35], v[148:151], v[112:115], v[32:35]
    v_exp_f32 v38, v38
    v_mfma_f32_16x16x32_bf16 v[32:35], v[104:107], v[92:95], v[32:35]
    v_exp_f32 v39, v39
    v_mfma_f32_16x16x32_bf16 v[32:35], v[116:119], v[136:139], v[32:35]
    v_add_f32 v36, 1.0, v36
    v_add_f32 v37, 1.0, v37
    v_mfma_f32_16x16x32_bf16 v[32:35], v[108:111], v[140:143], v[32:35]
    v_add_f32 v38, 1.0, v38
    v_add_f32 v39, 1.0, v39
    v_mfma_f32_16x16x32_bf16 v[32:35], v[124:127], v[152:155], v[32:35]
    v_rcp_f32 v36, v36
    s_waitcnt lgkmcnt(6)
    v_mfma_f32_16x16x32_bf16 v[32:35], v[144:147], v[156:159], v[32:35]
    v_rcp_f32 v37, v37
    v_mfma_f32_16x16x32_bf16 v[28:31], v[160:163], v[180:183], v[28:31]
    v_rcp_f32 v38, v38
    v_mfma_f32_16x16x32_bf16 v[28:31], v[168:171], v[100:103], v[28:31]
    v_rcp_f32 v39, v39
    v_mfma_f32_16x16x32_bf16 v[28:31], v[176:179], v[120:123], v[28:31]
    v_fma_f32 v36, v36, v49, v50
    v_fma_f32 v37, v37, v49, v50
    v_mfma_f32_16x16x32_bf16 v[28:31], v[128:131], v[188:191], v[28:31]
    v_fma_f32 v38, v38, v49, v50
    v_fma_f32 v39, v39, v49, v50
    v_mfma_f32_16x16x32_bf16 v[28:31], v[132:135], v[196:199], v[28:31]
    v_cvt_pk_f16_f32 v74, v36, v37
    v_cvt_pk_f16_f32 v75, v38, v39
    v_mfma_f32_16x16x32_bf16 v[28:31], v[184:187], v[204:207], v[28:31]
    v_mul_f32 v32, s56, v32
    v_mul_f32 v33, s56, v33
    v_mfma_f32_16x16x32_bf16 v[28:31], v[192:195], v[212:215], v[28:31]
    v_mul_f32 v34, s56, v34
    v_mul_f32 v35, s56, v35
    v_mfma_f32_16x16x32_bf16 v[28:31], v[200:203], v[96:99], v[28:31]
    v_exp_f32 v32, v32
    v_mfma_f32_16x16x32_bf16 v[28:31], v[208:211], v[112:115], v[28:31]
    v_exp_f32 v33, v33
    v_mfma_f32_16x16x32_bf16 v[28:31], v[148:151], v[92:95], v[28:31]
    v_exp_f32 v34, v34
    v_mfma_f32_16x16x32_bf16 v[28:31], v[104:107], v[136:139], v[28:31]
    v_exp_f32 v35, v35
    v_mfma_f32_16x16x32_bf16 v[28:31], v[116:119], v[140:143], v[28:31]
    v_add_f32 v32, 1.0, v32
    v_add_f32 v33, 1.0, v33
    v_mfma_f32_16x16x32_bf16 v[28:31], v[108:111], v[152:155], v[28:31]
    v_add_f32 v34, 1.0, v34
    v_add_f32 v35, 1.0, v35
    v_mfma_f32_16x16x32_bf16 v[28:31], v[124:127], v[156:159], v[28:31]
    v_rcp_f32 v32, v32
    s_waitcnt lgkmcnt(5)
    v_mfma_f32_16x16x32_bf16 v[28:31], v[144:147], v[216:219], v[28:31]
    v_rcp_f32 v33, v33
    v_mfma_f32_16x16x32_bf16 v[24:27], v[160:163], v[100:103], v[24:27]
    v_rcp_f32 v34, v34
    v_mfma_f32_16x16x32_bf16 v[24:27], v[168:171], v[120:123], v[24:27]
    v_rcp_f32 v35, v35
    v_mfma_f32_16x16x32_bf16 v[24:27], v[176:179], v[188:191], v[24:27]
    v_fma_f32 v32, v32, v49, v50
    v_fma_f32 v33, v33, v49, v50
    v_mfma_f32_16x16x32_bf16 v[24:27], v[128:131], v[196:199], v[24:27]
    v_fma_f32 v34, v34, v49, v50
    v_fma_f32 v35, v35, v49, v50
    v_mfma_f32_16x16x32_bf16 v[24:27], v[132:135], v[204:207], v[24:27]
    v_cvt_pk_f16_f32 v72, v32, v33
    v_cvt_pk_f16_f32 v73, v34, v35
    v_mfma_f32_16x16x32_bf16 v[24:27], v[184:187], v[212:215], v[24:27]
    v_mul_f32 v28, s56, v28
    v_permlane32_swap_b32 v72, v74
    v_mfma_f32_16x16x32_bf16 v[24:27], v[192:195], v[96:99], v[24:27]
    v_permlane32_swap_b32 v73, v75
    buffer_store_dwordx4 v[72:75], v48, s[20:23], s75 offen sc1
    v_mfma_f32_16x16x32_bf16 v[24:27], v[200:203], v[112:115], v[24:27]
    v_mul_f32 v29, s56, v29
    v_mul_f32 v30, s56, v30
    v_mfma_f32_16x16x32_bf16 v[24:27], v[208:211], v[92:95], v[24:27]
    v_mul_f32 v31, s56, v31
    v_mfma_f32_16x16x32_bf16 v[24:27], v[148:151], v[136:139], v[24:27]
    v_exp_f32 v28, v28
    v_mfma_f32_16x16x32_bf16 v[24:27], v[104:107], v[140:143], v[24:27]
    v_exp_f32 v29, v29
    v_mfma_f32_16x16x32_bf16 v[24:27], v[116:119], v[152:155], v[24:27]
    v_exp_f32 v30, v30
    v_mfma_f32_16x16x32_bf16 v[24:27], v[108:111], v[156:159], v[24:27]
    v_exp_f32 v31, v31
    v_mfma_f32_16x16x32_bf16 v[24:27], v[124:127], v[216:219], v[24:27]
    v_add_f32 v28, 1.0, v28
    v_add_f32 v29, 1.0, v29
    s_waitcnt lgkmcnt(4)
    v_mfma_f32_16x16x32_bf16 v[24:27], v[144:147], v[220:223], v[24:27]
    v_add_f32 v30, 1.0, v30
    v_add_f32 v31, 1.0, v31
    v_mfma_f32_16x16x32_bf16 v[20:23], v[160:163], v[120:123], v[20:23]
    v_rcp_f32 v28, v28
    v_mfma_f32_16x16x32_bf16 v[20:23], v[168:171], v[188:191], v[20:23]
    v_rcp_f32 v29, v29
    v_mfma_f32_16x16x32_bf16 v[20:23], v[176:179], v[196:199], v[20:23]
    v_rcp_f32 v30, v30
    v_mfma_f32_16x16x32_bf16 v[20:23], v[128:131], v[204:207], v[20:23]
    v_rcp_f32 v31, v31
    v_mfma_f32_16x16x32_bf16 v[20:23], v[132:135], v[212:215], v[20:23]
    v_fma_f32 v28, v28, v49, v50
    v_fma_f32 v29, v29, v49, v50
    v_mfma_f32_16x16x32_bf16 v[20:23], v[184:187], v[96:99], v[20:23]
    v_fma_f32 v30, v30, v49, v50
    v_fma_f32 v31, v31, v49, v50
    v_mfma_f32_16x16x32_bf16 v[20:23], v[192:195], v[112:115], v[20:23]
    v_cvt_pk_f16_f32 v70, v28, v29
    v_cvt_pk_f16_f32 v71, v30, v31
    v_mfma_f32_16x16x32_bf16 v[20:23], v[200:203], v[92:95], v[20:23]
    v_mul_f32 v24, s56, v24
    v_mul_f32 v25, s56, v25
    v_mfma_f32_16x16x32_bf16 v[20:23], v[208:211], v[136:139], v[20:23]
    v_mul_f32 v26, s56, v26
    v_mul_f32 v27, s56, v27
    v_mfma_f32_16x16x32_bf16 v[20:23], v[148:151], v[140:143], v[20:23]
    v_exp_f32 v24, v24
    v_mfma_f32_16x16x32_bf16 v[20:23], v[104:107], v[152:155], v[20:23]
    v_exp_f32 v25, v25
    v_mfma_f32_16x16x32_bf16 v[20:23], v[116:119], v[156:159], v[20:23]
    v_exp_f32 v26, v26
    v_mfma_f32_16x16x32_bf16 v[20:23], v[108:111], v[216:219], v[20:23]
    v_exp_f32 v27, v27
    v_mfma_f32_16x16x32_bf16 v[20:23], v[124:127], v[220:223], v[20:23]
    v_add_f32 v24, 1.0, v24
    v_add_f32 v25, 1.0, v25
    s_waitcnt lgkmcnt(3)
    v_mfma_f32_16x16x32_bf16 v[20:23], v[144:147], v[224:227], v[20:23]
    v_add_f32 v26, 1.0, v26
    v_add_f32 v27, 1.0, v27
    v_mfma_f32_16x16x32_bf16 v[16:19], v[160:163], v[188:191], v[16:19]
    v_rcp_f32 v24, v24
    v_mfma_f32_16x16x32_bf16 v[16:19], v[168:171], v[196:199], v[16:19]
    v_rcp_f32 v25, v25
    v_mfma_f32_16x16x32_bf16 v[16:19], v[176:179], v[204:207], v[16:19]
    v_rcp_f32 v26, v26
    v_mfma_f32_16x16x32_bf16 v[16:19], v[128:131], v[212:215], v[16:19]
    v_rcp_f32 v27, v27
    v_mfma_f32_16x16x32_bf16 v[16:19], v[132:135], v[96:99], v[16:19]
    v_fma_f32 v24, v24, v49, v50
    v_fma_f32 v25, v25, v49, v50
    v_mfma_f32_16x16x32_bf16 v[16:19], v[184:187], v[112:115], v[16:19]
    v_fma_f32 v26, v26, v49, v50
    v_fma_f32 v27, v27, v49, v50
    v_mfma_f32_16x16x32_bf16 v[16:19], v[192:195], v[92:95], v[16:19]
    v_cvt_pk_f16_f32 v68, v24, v25
    v_cvt_pk_f16_f32 v69, v26, v27
    v_mfma_f32_16x16x32_bf16 v[16:19], v[200:203], v[136:139], v[16:19]
    v_mul_f32 v20, s56, v20
    v_permlane32_swap_b32 v68, v70
    v_mfma_f32_16x16x32_bf16 v[16:19], v[208:211], v[140:143], v[16:19]
    v_permlane32_swap_b32 v69, v71
    buffer_store_dwordx4 v[68:71], v48, s[20:23], s74 offen sc1
    v_mfma_f32_16x16x32_bf16 v[16:19], v[148:151], v[152:155], v[16:19]
    v_mul_f32 v21, s56, v21
    v_mul_f32 v22, s56, v22
    v_mfma_f32_16x16x32_bf16 v[16:19], v[104:107], v[156:159], v[16:19]
    v_mul_f32 v23, s56, v23
    v_mfma_f32_16x16x32_bf16 v[16:19], v[116:119], v[216:219], v[16:19]
    v_exp_f32 v20, v20
    v_mfma_f32_16x16x32_bf16 v[16:19], v[108:111], v[220:223], v[16:19]
    v_exp_f32 v21, v21
    v_mfma_f32_16x16x32_bf16 v[16:19], v[124:127], v[224:227], v[16:19]
    v_exp_f32 v22, v22
    s_waitcnt lgkmcnt(2)
    v_mfma_f32_16x16x32_bf16 v[16:19], v[144:147], v[228:231], v[16:19]
    v_exp_f32 v23, v23
    v_mfma_f32_16x16x32_bf16 v[12:15], v[160:163], v[196:199], v[12:15]
    v_add_f32 v20, 1.0, v20
    v_add_f32 v21, 1.0, v21
    v_mfma_f32_16x16x32_bf16 v[12:15], v[168:171], v[204:207], v[12:15]
    v_add_f32 v22, 1.0, v22
    v_add_f32 v23, 1.0, v23
    v_mfma_f32_16x16x32_bf16 v[12:15], v[176:179], v[212:215], v[12:15]
    v_rcp_f32 v20, v20
    v_mfma_f32_16x16x32_bf16 v[12:15], v[128:131], v[96:99], v[12:15]
    v_rcp_f32 v21, v21
    v_mfma_f32_16x16x32_bf16 v[12:15], v[132:135], v[112:115], v[12:15]
    v_rcp_f32 v22, v22
    v_mfma_f32_16x16x32_bf16 v[12:15], v[184:187], v[92:95], v[12:15]
    v_rcp_f32 v23, v23
    v_mfma_f32_16x16x32_bf16 v[12:15], v[192:195], v[136:139], v[12:15]
    v_fma_f32 v20, v20, v49, v50
    v_fma_f32 v21, v21, v49, v50
    v_mfma_f32_16x16x32_bf16 v[12:15], v[200:203], v[140:143], v[12:15]
    v_fma_f32 v22, v22, v49, v50
    v_fma_f32 v23, v23, v49, v50
    v_mfma_f32_16x16x32_bf16 v[12:15], v[208:211], v[152:155], v[12:15]
    v_cvt_pk_f16_f32 v66, v20, v21
    v_cvt_pk_f16_f32 v67, v22, v23
    v_mfma_f32_16x16x32_bf16 v[12:15], v[148:151], v[156:159], v[12:15]
    v_mul_f32 v16, s56, v16
    v_mul_f32 v17, s56, v17
    v_mfma_f32_16x16x32_bf16 v[12:15], v[104:107], v[216:219], v[12:15]
    v_mul_f32 v18, s56, v18
    v_mul_f32 v19, s56, v19
    v_mfma_f32_16x16x32_bf16 v[12:15], v[116:119], v[220:223], v[12:15]
    v_exp_f32 v16, v16
    v_mfma_f32_16x16x32_bf16 v[12:15], v[108:111], v[224:227], v[12:15]
    v_exp_f32 v17, v17
    v_mfma_f32_16x16x32_bf16 v[12:15], v[124:127], v[228:231], v[12:15]
    v_exp_f32 v18, v18
    s_waitcnt lgkmcnt(1)
    v_mfma_f32_16x16x32_bf16 v[12:15], v[144:147], v[232:235], v[12:15]
    v_exp_f32 v19, v19
    v_mfma_f32_16x16x32_bf16 v[8:11], v[160:163], v[204:207], v[8:11]
    v_add_f32 v16, 1.0, v16
    v_add_f32 v17, 1.0, v17
    v_mfma_f32_16x16x32_bf16 v[8:11], v[168:171], v[212:215], v[8:11]
    v_add_f32 v18, 1.0, v18
    v_add_f32 v19, 1.0, v19
    v_mfma_f32_16x16x32_bf16 v[8:11], v[176:179], v[96:99], v[8:11]
    v_rcp_f32 v16, v16
    v_mfma_f32_16x16x32_bf16 v[8:11], v[128:131], v[112:115], v[8:11]
    v_rcp_f32 v17, v17
    v_mfma_f32_16x16x32_bf16 v[8:11], v[132:135], v[92:95], v[8:11]
    v_rcp_f32 v18, v18
    v_mfma_f32_16x16x32_bf16 v[8:11], v[184:187], v[136:139], v[8:11]
    v_rcp_f32 v19, v19
    v_mfma_f32_16x16x32_bf16 v[8:11], v[192:195], v[140:143], v[8:11]
    v_fma_f32 v16, v16, v49, v50
    v_fma_f32 v17, v17, v49, v50
    v_mfma_f32_16x16x32_bf16 v[8:11], v[200:203], v[152:155], v[8:11]
    v_fma_f32 v18, v18, v49, v50
    v_fma_f32 v19, v19, v49, v50
    v_mfma_f32_16x16x32_bf16 v[8:11], v[208:211], v[156:159], v[8:11]
    v_cvt_pk_f16_f32 v64, v16, v17
    v_cvt_pk_f16_f32 v65, v18, v19
    v_mfma_f32_16x16x32_bf16 v[8:11], v[148:151], v[216:219], v[8:11]
    v_mul_f32 v12, s56, v12
    v_permlane32_swap_b32 v64, v66
    v_mfma_f32_16x16x32_bf16 v[8:11], v[104:107], v[220:223], v[8:11]
    v_permlane32_swap_b32 v65, v67
    buffer_store_dwordx4 v[64:67], v48, s[20:23], s73 offen sc1
    v_mfma_f32_16x16x32_bf16 v[8:11], v[116:119], v[224:227], v[8:11]
    v_mul_f32 v13, s56, v13
    v_mul_f32 v14, s56, v14
    v_mfma_f32_16x16x32_bf16 v[8:11], v[108:111], v[228:231], v[8:11]
    v_mul_f32 v15, s56, v15
    v_mfma_f32_16x16x32_bf16 v[8:11], v[124:127], v[232:235], v[8:11]
    v_exp_f32 v12, v12
    s_waitcnt lgkmcnt(0)
    v_mfma_f32_16x16x32_bf16 v[8:11], v[144:147], v[236:239], v[8:11]
    v_exp_f32 v13, v13
    v_exp_f32 v14, v14
    v_exp_f32 v15, v15
    v_add_f32 v12, 1.0, v12
    v_add_f32 v13, 1.0, v13
    v_add_f32 v14, 1.0, v14
    v_add_f32 v15, 1.0, v15
    v_rcp_f32 v12, v12
    v_rcp_f32 v13, v13
    v_rcp_f32 v14, v14
    v_rcp_f32 v15, v15
    v_fma_f32 v12, v12, v49, v50
    v_fma_f32 v13, v13, v49, v50
    v_fma_f32 v14, v14, v49, v50
    v_fma_f32 v15, v15, v49, v50
    v_cvt_pk_f16_f32 v62, v12, v13
    v_cvt_pk_f16_f32 v63, v14, v15
    s_nop 0
    v_mul_f32 v8, s56, v8
    v_mul_f32 v9, s56, v9
    v_mul_f32 v10, s56, v10
    v_mul_f32 v11, s56, v11
    v_exp_f32 v8, v8
    v_exp_f32 v9, v9
    v_exp_f32 v10, v10
    v_exp_f32 v11, v11
    v_add_f32 v8, 1.0, v8
    v_add_f32 v9, 1.0, v9
    v_add_f32 v10, 1.0, v10
    v_add_f32 v11, 1.0, v11
    v_rcp_f32 v8, v8
    v_rcp_f32 v9, v9
    v_rcp_f32 v10, v10
    v_rcp_f32 v11, v11
    v_fma_f32 v8, v8, v49, v50
    v_fma_f32 v9, v9, v49, v50
    v_fma_f32 v10, v10, v49, v50
    v_fma_f32 v11, v11, v49, v50
    v_cvt_pk_f16_f32 v60, v8, v9
    v_cvt_pk_f16_f32 v61, v10, v11
    s_nop 1
    v_permlane32_swap_b32 v60, v62
    v_permlane32_swap_b32 v61, v63
    buffer_store_dwordx4 v[60:63], v48, s[20:23], s72 offen sc1
    s_barrier
    s_cmp_eq_u32 s51, 0
    s_cbranch_scc0 L_z1
    ds_read_b64_tr_b16 v[92:93], v54 offset:0
    ds_read_b64_tr_b16 v[94:95], v54 offset:2304
    ds_read_b64_tr_b16 v[96:97], v54 offset:9216
    ds_read_b64_tr_b16 v[98:99], v54 offset:11520
    ds_read_b64_tr_b16 v[100:101], v54 offset:18432
    ds_read_b64_tr_b16 v[102:103], v54 offset:20736
    ds_read_b64_tr_b16 v[104:105], v54 offset:27648
    ds_read_b64_tr_b16 v[106:107], v54 offset:29952
    ds_read_b64_tr_b16 v[108:109], v55 offset:36864
    s_waitcnt lgkmcnt(4)
    ds_read_b64_tr_b16 v[110:111], v54 offset:8
    ds_read_b64_tr_b16 v[112:113], v54 offset:2312
    ds_read_b64_tr_b16 v[114:115], v54 offset:9224
    ds_read_b64_tr_b16 v[116:117], v54 offset:11528
    ds_read_b64_tr_b16 v[118:119], v54 offset:18440
    ds_read_b64_tr_b16 v[120:121], v54 offset:20744
    ds_read_b64_tr_b16 v[122:123], v54 offset:27656
    ds_read_b64_tr_b16 v[124:125], v54 offset:29960
    ds_read_b64_tr_b16 v[126:127], v55 offset:36872
    s_waitcnt lgkmcnt(4)
    ds_read_b64_tr_b16 v[128:129], v54 offset:64
    ds_read_b64_tr_b16 v[130:131], v54 offset:2368
    ds_read_b64_tr_b16 v[132:133], v54 offset:9280
    ds_read_b64_tr_b16 v[134:135], v54 offset:11584
    ds_read_b64_tr_b16 v[136:137], v54 offset:18496
    ds_read_b64_tr_b16 v[138:139], v54 offset:20800
    ds_read_b64_tr_b16 v[140:141], v54 offset:27712
    ds_read_b64_tr_b16 v[142:143], v54 offset:30016
    ds_read_b64_tr_b16 v[144:145], v55 offset:36928
    s_waitcnt lgkmcnt(4)
    ds_read_b64_tr_b16 v[146:147], v54 offset:72
    ds_read_b64_tr_b16 v[148:149], v54 offset:2376
    ds_read_b64_tr_b16 v[150:151], v54 offset:9288
    ds_read_b64_tr_b16 v[152:153], v54 offset:11592
    ds_read_b64_tr_b16 v[154:155], v54 offset:18504
    ds_read_b64_tr_b16 v[156:157], v54 offset:20808
    ds_read_b64_tr_b16 v[158:159], v54 offset:27720
    ds_read_b64_tr_b16 v[160:161], v54 offset:30024
    ds_read_b64_tr_b16 v[162:163], v55 offset:36936
    s_waitcnt lgkmcnt(4)
    s_cmp_eq_u32 s59, 6
    s_cbranch_scc0 L_w0_5
    buffer_load_dwordx4 v[192:195], v51, s[20:23], s38 offen offset:2048 sc1
    buffer_load_dwordx4 v[204:207], v51, s[20:23], s39 offen offset:2048 sc1
    buffer_load_dwordx4 v[196:199], v51, s[20:23], s38 offen offset:3072 sc1
    buffer_load_dwordx4 v[208:211], v51, s[20:23], s39 offen offset:3072 sc1
L_w0_5:
    s_branch L_chk10
L_poll0:
    buffer_load_dwordx4 v[192:195], v51, s[20:23], s38 offen offset:2048 sc1
    buffer_load_dwordx4 v[204:207], v51, s[20:23], s39 offen offset:2048 sc1
    buffer_load_dwordx4 v[196:199], v51, s[20:23], s38 offen offset:3072 sc1
    buffer_load_dwordx4 v[208:211], v51, s[20:23], s39 offen offset:3072 sc1
L_chk10:
L_chk0:
    s_add_u32 s58, s58, 1
    s_waitcnt vmcnt(2) lgkmcnt(0)
    v_max3_f32 v68, 0, abs(v192), abs(v195)
    v_max3_f32 v68, v68, abs(v204), abs(v207)
    v_fma_mix_f32 v60, v192, v204, 0 op_sel_hi:[1,1,0]
    v_fma_mix_f32 v61, v192, v204, 0 op_sel:[1,1,0] op_sel_hi:[1,1,0]
    v_fma_mix_f32 v62, v193, v205, 0 op_sel_hi:[1,1,0]
    v_fma_mix_f32 v63, v193, v205, 0 op_sel:[1,1,0] op_sel_hi:[1,1,0]
    v_fma_mix_f32 v64, v194, v206, 0 op_sel_hi:[1,1,0]
    v_fma_mix_f32 v65, v194, v206, 0 op_sel:[1,1,0] op_sel_hi:[1,1,0]
    v_fma_mix_f32 v66, v195, v207, 0 op_sel_hi:[1,1,0]
    v_fma_mix_f32 v67, v195, v207, 0 op_sel:[1,1,0] op_sel_hi:[1,1,0]
    v_cvt_pk_bf16_f32 v192, v60, v61
    v_cvt_pk_bf16_f32 v193, v62, v63
    v_cvt_pk_bf16_f32 v194, v64, v65
    v_cvt_pk_bf16_f32 v195, v66, v67
    ds_write_b128 v53, v[192:195] offset:2048
    s_waitcnt vmcnt(0)
    v_max3_f32 v68, v68, abs(v196), abs(v199)
    v_max3_f32 v68, v68, abs(v208), abs(v211)
    v_mfma_f32_16x16x32_bf16 v[8:11], v[100:103], v[192:195], 0
    v_cmp_eq_u32 vcc, s57, v68
    v_mfma_f32_16x16x32_bf16 v[12:15], v[118:121], v[192:195], 0
    v_fma_mix_f32 v60, v196, v208, 0 op_sel_hi:[1,1,0]
    v_mfma_f32_16x16x32_bf16 v[16:19], v[136:139], v[192:195], 0
    v_fma_mix_f32 v61, v196, v208, 0 op_sel:[1,1,0] op_sel_hi:[1,1,0]
    v_mfma_f32_16x16x32_bf16 v[20:23], v[154:157], v[192:195], 0
    v_fma_mix_f32 v62, v197, v209, 0 op_sel_hi:[1,1,0]
    v_fma_mix_f32 v63, v197, v209, 0 op_sel:[1,1,0] op_sel_hi:[1,1,0]
    v_fma_mix_f32 v64, v198, v210, 0 op_sel_hi:[1,1,0]
    v_fma_mix_f32 v65, v198, v210, 0 op_sel:[1,1,0] op_sel_hi:[1,1,0]
    v_fma_mix_f32 v66, v199, v211, 0 op_sel_hi:[1,1,0]
    v_fma_mix_f32 v67, v199, v211, 0 op_sel:[1,1,0] op_sel_hi:[1,1,0]
    v_cvt_pk_bf16_f32 v196, v60, v61
    v_cvt_pk_bf16_f32 v197, v62, v63
    v_cvt_pk_bf16_f32 v198, v64, v65
    v_cvt_pk_bf16_f32 v199, v66, v67
    ds_write_b128 v53, v[196:199] offset:3072
    s_cbranch_vccz L_go0
    s_cmp_gt_u32 s58, 20000
    s_cbranch_scc1 L_go0
    s_cmp_lt_u32 s41, 0
    s_cbranch_scc1 L_poll0
    s_branch L_poll0
L_go0:
    s_waitcnt lgkmcnt(0)
    s_barrier
    ds_read_b128 v[184:187], v53 offset:0
    ds_read_b128 v[188:191], v53 offset:1024
    ds_read_b64 v[200:201], v53 offset:4096
    v_mfma_f32_16x16x32_bf16 v[8:11], v[104:107], v[196:199], v[8:11]
    v_mfma_f32_16x16x32_bf16 v[12:15], v[122:125], v[196:199], v[12:15]
    v_mfma_f32_16x16x32_bf16 v[16:19], v[140:143], v[196:199], v[16:19]
    v_mfma_f32_16x16x32_bf16 v[20:23], v[158:161], v[196:199], v[20:23]
    s_waitcnt lgkmcnt(2)
    v_mfma_f32_16x16x32_bf16 v[8:11], v[92:95], v[184:187], v[8:11]
    v_mfma_f32_16x16x32_bf16 v[12:15], v[110:113], v[184:187], v[12:15]
    v_mfma_f32_16x16x32_bf16 v[16:19], v[128:131], v[184:187], v[16:19]
    v_mfma_f32_16x16x32_bf16 v[20:23], v[146:149], v[184:187], v[20:23]
    s_waitcnt lgkmcnt(1)
    v_mfma_f32_16x16x32_bf16 v[8:11], v[96:99], v[188:191], v[8:11]
    v_mfma_f32_16x16x32_bf16 v[12:15], v[114:117], v[188:191], v[12:15]
    v_mfma_f32_16x16x32_bf16 v[16:19], v[132:135], v[188:191], v[16:19]
    v_mfma_f32_16x16x32_bf16 v[20:23], v[150:153], v[188:191], v[20:23]
    s_waitcnt lgkmcnt(0)
    v_mfma_f32_16x16x16_bf16 v[8:11], v[108:109], v[200:201], v[8:11]
    v_mfma_f32_16x16x16_bf16 v[12:15], v[126:127], v[200:201], v[12:15]
    v_mfma_f32_16x16x16_bf16 v[16:19], v[144:145], v[200:201], v[16:19]
    v_mfma_f32_16x16x16_bf16 v[20:23], v[162:163], v[200:201], v[20:23]
    s_nop 4
    v_cvt_pk_bf16_f32 v60, v8, v9
    v_cvt_pk_bf16_f32 v61, v10, v11
    v_cvt_pk_bf16_f32 v62, v12, v13
    v_cvt_pk_bf16_f32 v63, v14, v15
    ds_write_b128 v58, v[60:63] offset:0
    v_cvt_pk_bf16_f32 v64, v16, v17
    v_cvt_pk_bf16_f32 v65, v18, v19
    v_cvt_pk_bf16_f32 v66, v20, v21
    v_cvt_pk_bf16_f32 v67, v22, v23
    ds_write_b128 v58, v[64:67] offset:64
    s_waitcnt lgkmcnt(0)
    s_barrier
    ds_read_b128 v[8:11], v84
    ds_read_b128 v[12:15], v85
    s_cmp_eq_u32 s3, 0
    s_cbranch_scc0 L_two
    ds_read_b128 v[16:19], v86
    s_waitcnt lgkmcnt(0)
    buffer_store_dwordx4 v[16:19], v89, s[28:31], 0 offen sc1
L_two:
    s_waitcnt lgkmcnt(1)
    buffer_store_dwordx4 v[8:11], v87, s[28:31], 0 offen sc1
    s_waitcnt lgkmcnt(0)
    buffer_store_dwordx4 v[12:15], v88, s[28:31], 0 offen sc1
    s_endpgm
L_z1:
    ds_read_b64_tr_b16 v[92:93], v54 offset:0
    ds_read_b64_tr_b16 v[94:95], v54 offset:2304
    ds_read_b64_tr_b16 v[96:97], v54 offset:9216
    ds_read_b64_tr_b16 v[98:99], v54 offset:11520
    ds_read_b64_tr_b16 v[100:101], v54 offset:18432
    ds_read_b64_tr_b16 v[102:103], v54 offset:20736
    ds_read_b64_tr_b16 v[104:105], v54 offset:27648
    ds_read_b64_tr_b16 v[106:107], v54 offset:29952
    ds_read_b64_tr_b16 v[108:109], v55 offset:36864
    s_waitcnt lgkmcnt(4)
    ds_read_b64_tr_b16 v[110:111], v54 offset:8
    ds_read_b64_tr_b16 v[112:113], v54 offset:2312
    ds_read_b64_tr_b16 v[114:115], v54 offset:9224
    ds_read_b64_tr_b16 v[116:117], v54 offset:11528
    ds_read_b64_tr_b16 v[118:119], v54 offset:18440
    ds_read_b64_tr_b16 v[120:121], v54 offset:20744
    ds_read_b64_tr_b16 v[122:123], v54 offset:27656
    ds_read_b64_tr_b16 v[124:125], v54 offset:29960
    ds_read_b64_tr_b16 v[126:127], v55 offset:36872
    s_waitcnt lgkmcnt(4)
    ds_read_b64_tr_b16 v[128:129], v54 offset:64
    ds_read_b64_tr_b16 v[130:131], v54 offset:2368
    ds_read_b64_tr_b16 v[132:133], v54 offset:9280
    ds_read_b64_tr_b16 v[134:135], v54 offset:11584
    ds_read_b64_tr_b16 v[136:137], v54 offset:18496
    ds_read_b64_tr_b16 v[138:139], v54 offset:20800
    ds_read_b64_tr_b16 v[140:141], v54 offset:27712
    ds_read_b64_tr_b16 v[142:143], v54 offset:30016
    ds_read_b64_tr_b16 v[144:145], v55 offset:36928
    s_waitcnt lgkmcnt(4)
    ds_read_b64_tr_b16 v[146:147], v54 offset:72
    ds_read_b64_tr_b16 v[148:149], v54 offset:2376
    ds_read_b64_tr_b16 v[150:151], v54 offset:9288
    ds_read_b64_tr_b16 v[152:153], v54 offset:11592
    ds_read_b64_tr_b16 v[154:155], v54 offset:18504
    ds_read_b64_tr_b16 v[156:157], v54 offset:20808
    ds_read_b64_tr_b16 v[158:159], v54 offset:27720
    ds_read_b64_tr_b16 v[160:161], v54 offset:30024
    ds_read_b64_tr_b16 v[162:163], v55 offset:36936
    s_waitcnt lgkmcnt(4)
    ds_read_b64_tr_b16 v[164:165], v56 offset:256
    ds_read_b64_tr_b16 v[166:167], v56 offset:2560
    ds_read_b64_tr_b16 v[168:169], v56 offset:9472
    ds_read_b64_tr_b16 v[170:171], v56 offset:11776
    ds_read_b64_tr_b16 v[172:173], v56 offset:18688
    ds_read_b64_tr_b16 v[174:175], v56 offset:20992
    ds_read_b64_tr_b16 v[176:177], v56 offset:27904
    ds_read_b64_tr_b16 v[178:179], v56 offset:30208
    ds_read_b64_tr_b16 v[180:181], v57 offset:37120
    s_waitcnt lgkmcnt(4)
    s_cmp_eq_u32 s59, 6
    s_cbranch_scc0 L_w1_5
    buffer_load_dwordx4 v[184:187], v51, s[20:23], s38 offen offset:0 sc1
    buffer_load_dwordx4 v[204:207], v51, s[20:23], s39 offen offset:0 sc1
    buffer_load_dwordx4 v[188:191], v51, s[20:23], s38 offen offset:1024 sc1
    buffer_load_dwordx4 v[208:211], v51, s[20:23], s39 offen offset:1024 sc1
    buffer_load_dwordx2 v[200:201], v52, s[20:23], s77 offen sc1
    buffer_load_dwordx2 v[212:213], v52, s[20:23], s78 offen sc1
L_w1_5:
    s_branch L_chk11
L_poll1:
    buffer_load_dwordx4 v[184:187], v51, s[20:23], s38 offen offset:0 sc1
    buffer_load_dwordx4 v[204:207], v51, s[20:23], s39 offen offset:0 sc1
    buffer_load_dwordx4 v[188:191], v51, s[20:23], s38 offen offset:1024 sc1
    buffer_load_dwordx4 v[208:211], v51, s[20:23], s39 offen offset:1024 sc1
    buffer_load_dwordx2 v[200:201], v52, s[20:23], s77 offen sc1
    buffer_load_dwordx2 v[212:213], v52, s[20:23], s78 offen sc1
L_chk11:
L_chk1:
    s_add_u32 s58, s58, 1
    s_waitcnt vmcnt(4) lgkmcnt(0)
    v_max3_f32 v68, 0, abs(v184), abs(v187)
    v_max3_f32 v68, v68, abs(v204), abs(v207)
    v_fma_mix_f32 v60, v184, v204, 0 op_sel_hi:[1,1,0]
    v_fma_mix_f32 v61, v184, v204, 0 op_sel:[1,1,0] op_sel_hi:[1,1,0]
    v_fma_mix_f32 v62, v185, v205, 0 op_sel_hi:[1,1,0]
    v_fma_mix_f32 v63, v185, v205, 0 op_sel:[1,1,0] op_sel_hi:[1,1,0]
    v_fma_mix_f32 v64, v186, v206, 0 op_sel_hi:[1,1,0]
    v_fma_mix_f32 v65, v186, v206, 0 op_sel:[1,1,0] op_sel_hi:[1,1,0]
    v_fma_mix_f32 v66, v187, v207, 0 op_sel_hi:[1,1,0]
    v_fma_mix_f32 v67, v187, v207, 0 op_sel:[1,1,0] op_sel_hi:[1,1,0]
    v_cvt_pk_bf16_f32 v184, v60, v61
    v_cvt_pk_bf16_f32 v185, v62, v63
    v_cvt_pk_bf16_f32 v186, v64, v65
    v_cvt_pk_bf16_f32 v187, v66, v67
    ds_write_b128 v53, v[184:187] offset:0
    s_waitcnt vmcnt(2)
    v_max3_f32 v68, v68, abs(v188), abs(v191)
    v_max3_f32 v68, v68, abs(v208), abs(v211)
    v_mfma_f32_16x16x32_bf16 v[8:11], v[92:95], v[184:187], 0
    v_fma_mix_f32 v60, v188, v208, 0 op_sel_hi:[1,1,0]
    v_mfma_f32_16x16x32_bf16 v[12:15], v[110:113], v[184:187], 0
    v_fma_mix_f32 v61, v188, v208, 0 op_sel:[1,1,0] op_sel_hi:[1,1,0]
    v_mfma_f32_16x16x32_bf16 v[16:19], v[128:131], v[184:187], 0
    v_fma_mix_f32 v62, v189, v209, 0 op_sel_hi:[1,1,0]
    v_mfma_f32_16x16x32_bf16 v[20:23], v[146:149], v[184:187], 0
    v_fma_mix_f32 v63, v189, v209, 0 op_sel:[1,1,0] op_sel_hi:[1,1,0]
    v_mfma_f32_16x16x32_bf16 v[24:27], v[164:167], v[184:187], 0
    v_fma_mix_f32 v64, v190, v210, 0 op_sel_hi:[1,1,0]
    v_fma_mix_f32 v65, v190, v210, 0 op_sel:[1,1,0] op_sel_hi:[1,1,0]
    v_fma_mix_f32 v66, v191, v211, 0 op_sel_hi:[1,1,0]
    v_fma_mix_f32 v67, v191, v211, 0 op_sel:[1,1,0] op_sel_hi:[1,1,0]
    v_cvt_pk_bf16_f32 v188, v60, v61
    v_cvt_pk_bf16_f32 v189, v62, v63
    v_cvt_pk_bf16_f32 v190, v64, v65
    v_cvt_pk_bf16_f32 v191, v66, v67
    ds_write_b128 v53, v[188:191] offset:1024
    s_waitcnt vmcnt(0)
    v_max3_f32 v68, v68, abs(v200), abs(v201)
    v_max3_f32 v68, v68, abs(v212), abs(v213)
    v_mfma_f32_16x16x32_bf16 v[8:11], v[96:99], v[188:191], v[8:11]
    v_cmp_eq_u32 vcc, s57, v68
    v_mfma_f32_16x16x32_bf16 v[12:15], v[114:117], v[188:191], v[12:15]
    v_fma_mix_f32 v60, v200, v212, 0 op_sel_hi:[1,1,0]
    v_mfma_f32_16x16x32_bf16 v[16:19], v[132:135], v[188:191], v[16:19]
    v_fma_mix_f32 v61, v200, v212, 0 op_sel:[1,1,0] op_sel_hi:[1,1,0]
    v_mfma_f32_16x16x32_bf16 v[20:23], v[150:153], v[188:191], v[20:23]
    v_fma_mix_f32 v62, v201, v213, 0 op_sel_hi:[1,1,0]
    v_mfma_f32_16x16x32_bf16 v[24:27], v[168:171], v[188:191], v[24:27]
    v_fma_mix_f32 v63, v201, v213, 0 op_sel:[1,1,0] op_sel_hi:[1,1,0]
    v_cvt_pk_bf16_f32 v200, v60, v61
    v_cvt_pk_bf16_f32 v201, v62, v63
    ds_write_b64 v53, v[200:201] offset:4096
    s_cbranch_vccz L_go1
    s_cmp_gt_u32 s58, 20000
    s_cbranch_scc1 L_go1
    s_cmp_lt_u32 s41, 0
    s_cbranch_scc1 L_poll1
    s_branch L_poll1
L_go1:
    s_waitcnt lgkmcnt(0)
    s_barrier
    ds_read_b128 v[192:195], v53 offset:2048
    ds_read_b128 v[196:199], v53 offset:3072
    v_mfma_f32_16x16x16_bf16 v[8:11], v[108:109], v[200:201], v[8:11]
    v_mfma_f32_16x16x16_bf16 v[12:15], v[126:127], v[200:201], v[12:15]
    v_mfma_f32_16x16x16_bf16 v[16:19], v[144:145], v[200:201], v[16:19]
    v_mfma_f32_16x16x16_bf16 v[20:23], v[162:163], v[200:201], v[20:23]
    v_mfma_f32_16x16x16_bf16 v[24:27], v[180:181], v[200:201], v[24:27]
    s_waitcnt lgkmcnt(1)
    v_mfma_f32_16x16x32_bf16 v[8:11], v[100:103], v[192:195], v[8:11]
    v_mfma_f32_16x16x32_bf16 v[12:15], v[118:121], v[192:195], v[12:15]
    v_mfma_f32_16x16x32_bf16 v[16:19], v[136:139], v[192:195], v[16:19]
    v_mfma_f32_16x16x32_bf16 v[20:23], v[154:157], v[192:195], v[20:23]
    v_mfma_f32_16x16x32_bf16 v[24:27], v[172:175], v[192:195], v[24:27]
    s_waitcnt lgkmcnt(0)
    v_mfma_f32_16x16x32_bf16 v[8:11], v[104:107], v[196:199], v[8:11]
    v_mfma_f32_16x16x32_bf16 v[12:15], v[122:125], v[196:199], v[12:15]
    v_mfma_f32_16x16x32_bf16 v[16:19], v[140:143], v[196:199], v[16:19]
    v_mfma_f32_16x16x32_bf16 v[20:23], v[158:161], v[196:199], v[20:23]
    v_mfma_f32_16x16x32_bf16 v[24:27], v[176:179], v[196:199], v[24:27]
    s_nop 4
    v_cvt_pk_bf16_f32 v60, v8, v9
    v_cvt_pk_bf16_f32 v61, v10, v11
    v_cvt_pk_bf16_f32 v62, v12, v13
    v_cvt_pk_bf16_f32 v63, v14, v15
    ds_write_b128 v58, v[60:63] offset:0
    v_cvt_pk_bf16_f32 v64, v16, v17
    v_cvt_pk_bf16_f32 v65, v18, v19
    v_cvt_pk_bf16_f32 v66, v20, v21
    v_cvt_pk_bf16_f32 v67, v22, v23
    ds_write_b128 v58, v[64:67] offset:64
    v_cvt_pk_bf16_f32 v68, v24, v25
    v_cvt_pk_bf16_f32 v69, v26, v27
    ds_write_b64 v59, v[68:69] offset:256
    s_waitcnt lgkmcnt(0)
    s_barrier
    ds_read_b128 v[8:11], v84
    ds_read_b128 v[12:15], v85
    s_waitcnt lgkmcnt(1)
    buffer_store_dwordx4 v[8:11], v87, s[28:31], 0 offen sc1
    s_waitcnt lgkmcnt(0)
    buffer_store_dwordx4 v[12:15], v88, s[28:31], 0 offen sc1
    s_endpgm
L_helper2:
    s_cmp_eq_u32 s41, 0
    s_cbranch_scc0 L_nolead2
    v_mov_b32 v5, 0
    v_mov_b32 v6, 1
    s_mov_b64 exec, 1
    global_store_dword v5, v6, s[52:53] sc1
    s_mov_b64 exec, -1
L_nolead2:
    s_barrier
    s_barrier
    s_mov_b32 exec_lo, 4294967295
    s_mov_b32 exec_hi, 3
    s_mov_b32 s47, 73728
    buffer_load_dword v16, v14, s[16:19], s47 offen
    s_mov_b64 exec, -1
    s_mov_b32 s47, 36864
    buffer_load_dword v16, v13, s[16:19], s47 offen
    s_mov_b32 exec_lo, 15
    s_mov_b32 exec_hi, 0
    s_mov_b32 s47, 36864
    buffer_load_dword v16, v15, s[16:19], s47 offen
    s_mov_b64 exec, -1
    s_barrier
    s_mov_b32 s47, 55296
    buffer_load_dword v16, v13, s[16:19], s47 offen
    s_mov_b32 exec_lo, 15
    s_mov_b32 exec_hi, 0
    s_mov_b32 s47, 55296
    buffer_load_dword v16, v15, s[16:19], s47 offen
    s_mov_b64 exec, -1
    v_lshlrev_b32 v4, 7, v2
    s_mul_i32 s48, s79, 1408
    s_add_u32 s49, s45, 8064
    s_mov_b32 s32, s8
    s_and_b32 s33, s9, 0xffff
    s_mov_b32 s34, 41472
    s_mov_b32 s35, 0x20000
    s_mov_b32 exec_lo, 2047
    s_mov_b32 exec_hi, 0
    buffer_load_dword v7, v4, s[32:35], s48 offen
    s_mov_b64 exec, -1
    s_barrier
    s_barrier
    s_add_u32 s47, s38, 0
    buffer_store_dwordx4 v[24:27], v3, s[20:23], s47 offen sc1
    s_add_u32 s47, s38, 3072
    buffer_store_dwordx4 v[24:27], v3, s[20:23], s47 offen sc1
    s_add_u32 s47, s38, 6144
    buffer_store_dwordx4 v[24:27], v3, s[20:23], s47 offen sc1
    s_barrier
    v_mov_b32 v5, 0
    s_mov_b64 exec, 1
    global_load_dword v7, v5, s[52:53]
    s_mov_b64 exec, -1
    s_add_u32 s47, s38, 9216
    buffer_store_dwordx4 v[24:27], v3, s[20:23], s47 offen sc1
    s_add_u32 s47, s38, 12288
    buffer_store_dwordx4 v[24:27], v3, s[20:23], s47 offen sc1
    s_add_u32 s47, s38, 15360
    buffer_store_dwordx4 v[24:27], v3, s[20:23], s47 offen sc1
    s_barrier
    s_mov_b32 s58, 0
L_l1:
    s_waitcnt vmcnt(3)
    v_readfirstlane_b32 s50, v7
    s_add_u32 s58, s58, 1
    s_cmp_lg_u32 s50, 0
    s_cbranch_scc1 L_l1_go
    s_cmp_gt_u32 s58, 20000
    s_cbranch_scc1 L_l1_go
    s_mov_b64 exec, 1
    global_load_dword v7, v5, s[52:53] sc1
    s_mov_b64 exec, -1
    s_waitcnt vmcnt(0)
    s_branch L_l1
L_l1_go:
    s_barrier
    s_waitcnt vmcnt(0)
    v_mov_b32 v5, 0
    v_mov_b32 v6, 1
    s_mov_b64 exec, 1
    global_atomic_add v5, v6, s[54:55] sc1
    s_mov_b64 exec, -1
    s_barrier
    s_mov_b64 exec, 1
    global_load_dword v7, v5, s[54:55] sc1
    s_mov_b64 exec, -1
    s_barrier
    s_mov_b32 s58, 0
L_l2:
    s_waitcnt vmcnt(0)
    v_readfirstlane_b32 s50, v7
    s_add_u32 s58, s58, 1
    s_cmp_ge_u32 s50, 27
    s_cbranch_scc1 L_l2_go
    s_cmp_gt_u32 s58, 20000
    s_cbranch_scc1 L_l2_go
    s_mov_b64 exec, 1
    global_load_dword v7, v5, s[54:55] sc1
    s_mov_b64 exec, -1
    s_waitcnt vmcnt(0)
    s_branch L_l2
L_l2_go:
    s_barrier
    s_mov_b32 m0, 0
    s_mov_b32 s47, 0
    buffer_load_dwordx4 v3, s[32:35], s47 offen offset:0 lds
    buffer_load_dwordx4 v3, s[32:35], s47 offen offset:1024 lds
    buffer_load_dwordx4 v3, s[32:35], s47 offen offset:2048 lds
    buffer_load_dwordx4 v3, s[32:35], s47 offen offset:3072 lds
    s_mov_b32 m0, 4096
    s_mov_b32 s47, 4096
    buffer_load_dwordx4 v3, s[32:35], s47 offen offset:0 lds
    buffer_load_dwordx4 v3, s[32:35], s47 offen offset:1024 lds
    buffer_load_dwordx4 v3, s[32:35], s47 offen offset:2048 lds
    buffer_load_dwordx4 v3, s[32:35], s47 offen offset:3072 lds
    s_mov_b32 m0, 8192
    s_mov_b32 s47, 8192
    buffer_load_dwordx4 v3, s[32:35], s47 offen offset:0 lds
    buffer_load_dwordx4 v3, s[32:35], s47 offen offset:1024 lds
    buffer_load_dwordx4 v3, s[32:35], s47 offen offset:2048 lds
    buffer_load_dwordx4 v3, s[32:35], s47 offen offset:3072 lds
    s_mov_b32 m0, 12288
    s_mov_b32 s47, 12288
    buffer_load_dwordx4 v3, s[32:35], s47 offen offset:0 lds
    buffer_load_dwordx4 v3, s[32:35], s47 offen offset:1024 lds
    buffer_load_dwordx4 v3, s[32:35], s47 offen offset:2048 lds
    buffer_load_dwordx4 v3, s[32:35], s47 offen offset:3072 lds
    s_mov_b32 m0, 16384
    s_mov_b32 s47, 16384
    buffer_load_dwordx4 v3, s[32:35], s47 offen offset:0 lds
    buffer_load_dwordx4 v3, s[32:35], s47 offen offset:1024 lds
    buffer_load_dwordx4 v3, s[32:35], s47 offen offset:2048 lds
    buffer_load_dwordx4 v3, s[32:35], s47 offen offset:3072 lds
    s_mov_b32 m0, 20480
    s_mov_b32 s47, 20480
    buffer_load_dwordx4 v3, s[32:35], s47 offen offset:0 lds
    s_waitcnt vmcnt(0)
    s_barrier
    s_endpgm
L_extra:
    s_waitcnt lgkmcnt(0)
    s_mov_b32 s20, s26
    s_and_b32 s21, s27, 0xffff
    s_mov_b32 s22, 4648448
    s_mov_b32 s23, 0x20000
    v_lshlrev_b32 v3, 4, v2
    v_mov_b32 v24, 1140868096
    v_mov_b32 v25, v24
    v_mov_b32 v26, v24
    v_mov_b32 v27, v24
    s_lshl_b32 s47, s40, 7
    s_add_u32 s47, s47, 4644864
    s_add_u32 s54, s26, s47
    s_addc_u32 s55, s27, 0
    s_sub_u32 s47, s3, 5
    s_lshl_b32 s47, s47, 10
    s_add_u32 s38, s38, s47
    s_barrier
    s_barrier
    s_barrier
    s_barrier
    s_barrier
    s_barrier
    s_add_u32 s47, s38, 0
    buffer_store_dwordx4 v[24:27], v3, s[20:23], s47 offen sc1
    s_add_u32 s47, s38, 3072
    buffer_store_dwordx4 v[24:27], v3, s[20:23], s47 offen sc1
    s_add_u32 s47, s38, 6144
    buffer_store_dwordx4 v[24:27], v3, s[20:23], s47 offen sc1
    s_barrier
    s_add_u32 s47, s38, 9216
    buffer_store_dwordx4 v[24:27], v3, s[20:23], s47 offen sc1
    s_add_u32 s47, s38, 12288
    buffer_store_dwordx4 v[24:27], v3, s[20:23], s47 offen sc1
    s_add_u32 s47, s38, 15360
    buffer_store_dwordx4 v[24:27], v3, s[20:23], s47 offen sc1
    s_barrier
    s_barrier
    s_waitcnt vmcnt(0)
    v_mov_b32 v5, 0
    v_mov_b32 v6, 1
    s_mov_b64 exec, 1
    global_atomic_add v5, v6, s[54:55] sc1
    s_mov_b64 exec, -1
    s_barrier
    s_barrier
    s_waitcnt vmcnt(0) lgkmcnt(0)
    s_endpgm
L_loader2:
    s_waitcnt vmcnt(0)
    s_mov_b32 m0, 0
    s_add_u32 s47, s46, 0
    buffer_load_dwordx4 v3, s[16:19], s47 offen lds
    s_mov_b32 m0, 1024
    s_add_u32 s47, s46, 9216
    buffer_load_dwordx4 v3, s[16:19], s47 offen lds
    s_mov_b32 m0, 2048
    s_add_u32 s47, s46, 82944
    buffer_load_dwordx4 v3, s[16:19], s47 offen lds
    s_mov_b32 m0, 3072
    s_add_u32 s47, s46, 92160
    buffer_load_dwordx4 v3, s[16:19], s47 offen lds
    s_mov_b32 m0, 4096
    s_add_u32 s47, s46, 165888
    buffer_load_dwordx4 v3, s[16:19], s47 offen lds
    s_mov_b32 m0, 5120
    s_add_u32 s47, s46, 175104
    buffer_load_dwordx4 v3, s[16:19], s47 offen lds
    s_mov_b32 m0, 6144
    s_add_u32 s47, s46, 248832
    buffer_load_dwordx4 v3, s[16:19], s47 offen lds
    s_mov_b32 m0, 7168
    s_add_u32 s47, s46, 258048
    buffer_load_dwordx4 v3, s[16:19], s47 offen lds
    s_mov_b32 m0, 8192
    s_add_u32 s47, s46, 331776
    buffer_load_dwordx4 v3, s[16:19], s47 offen lds
    s_mov_b32 m0, 9216
    s_add_u32 s47, s46, 340992
    buffer_load_dwordx4 v3, s[16:19], s47 offen lds
    s_mov_b32 m0, 10240
    s_add_u32 s47, s46, 414720
    buffer_load_dwordx4 v3, s[16:19], s47 offen lds
    s_mov_b32 m0, 11264
    s_add_u32 s47, s46, 423936
    buffer_load_dwordx4 v3, s[16:19], s47 offen lds
    s_mov_b32 m0, 12288
    s_add_u32 s47, s46, 497664
    buffer_load_dwordx4 v3, s[16:19], s47 offen lds
    s_mov_b32 m0, 13312
    s_add_u32 s47, s46, 506880
    buffer_load_dwordx4 v3, s[16:19], s47 offen lds
    s_mov_b32 m0, 14336
    s_add_u32 s47, s46, 580608
    buffer_load_dwordx4 v3, s[16:19], s47 offen lds
    s_mov_b32 m0, 15360
    s_add_u32 s47, s46, 589824
    buffer_load_dwordx4 v3, s[16:19], s47 offen lds
    s_mov_b32 m0, 16384
    s_add_u32 s47, s46, 663552
    buffer_load_dwordx4 v3, s[16:19], s47 offen lds
    s_mov_b32 m0, 17408
    s_add_u32 s47, s46, 672768
    buffer_load_dwordx4 v3, s[16:19], s47 offen lds
    s_mov_b32 m0, 18432
    s_add_u32 s47, s46, 746496
    buffer_load_dwordx4 v3, s[16:19], s47 offen lds
    s_mov_b32 m0, 19456
    s_add_u32 s47, s46, 755712
    buffer_load_dwordx4 v3, s[16:19], s47 offen lds
    s_waitcnt vmcnt(12)
    s_barrier
    s_mov_b32 m0, 20480
    s_add_u32 s47, s46, 829440
    buffer_load_dwordx4 v3, s[16:19], s47 offen lds
    s_mov_b32 m0, 21504
    s_add_u32 s47, s46, 838656
    buffer_load_dwordx4 v3, s[16:19], s47 offen lds
    s_mov_b32 m0, 22528
    s_add_u32 s47, s46, 912384
    buffer_load_dwordx4 v3, s[16:19], s47 offen lds
    s_mov_b32 m0, 23552
    s_add_u32 s47, s46, 921600
    buffer_load_dwordx4 v3, s[16:19], s47 offen lds
    s_mov_b32 m0, 24576
    s_add_u32 s47, s46, 995328
    buffer_load_dwordx4 v3, s[16:19], s47 offen lds
    s_mov_b32 m0, 25600
    s_add_u32 s47, s46, 1004544
    buffer_load_dwordx4 v3, s[16:19], s47 offen lds
    s_mov_b32 m0, 26624
    s_add_u32 s47, s46, 1078272
    buffer_load_dwordx4 v3, s[16:19], s47 offen lds
    s_mov_b32 m0, 27648
    s_add_u32 s47, s46, 1087488
    buffer_load_dwordx4 v3, s[16:19], s47 offen lds
    s_mov_b32 m0, 28672
    s_add_u32 s47, s46, 1161216
    buffer_load_dwordx4 v3, s[16:19], s47 offen lds
    s_mov_b32 m0, 29696
    s_add_u32 s47, s46, 1170432
    buffer_load_dwordx4 v3, s[16:19], s47 offen lds
    s_mov_b32 m0, 30720
    s_add_u32 s47, s46, 18432
    buffer_load_dwordx4 v3, s[16:19], s47 offen lds
    s_mov_b32 m0, 31744
    s_add_u32 s47, s46, 27648
    buffer_load_dwordx4 v3, s[16:19], s47 offen lds
    s_waitcnt vmcnt(16)
    s_barrier
    s_mov_b32 m0, 32768
    s_add_u32 s47, s46, 101376
    buffer_load_dwordx4 v3, s[16:19], s47 offen lds
    s_mov_b32 m0, 33792
    s_add_u32 s47, s46, 110592
    buffer_load_dwordx4 v3, s[16:19], s47 offen lds
    s_mov_b32 m0, 34816
    s_add_u32 s47, s46, 184320
    buffer_load_dwordx4 v3, s[16:19], s47 offen lds
    s_mov_b32 m0, 35840
    s_add_u32 s47, s46, 193536
    buffer_load_dwordx4 v3, s[16:19], s47 offen lds
    s_mov_b32 m0, 36864
    s_add_u32 s47, s46, 267264
    buffer_load_dwordx4 v3, s[16:19], s47 offen lds
    s_mov_b32 m0, 37888
    s_add_u32 s47, s46, 276480
    buffer_load_dwordx4 v3, s[16:19], s47 offen lds
    s_mov_b32 m0, 38912
    s_add_u32 s47, s46, 350208
    buffer_load_dwordx4 v3, s[16:19], s47 offen lds
    s_mov_b32 m0, 39936
    s_add_u32 s47, s46, 359424
    buffer_load_dwordx4 v3, s[16:19], s47 offen lds
    s_mov_b32 m0, 40960
    s_add_u32 s47, s46, 433152
    buffer_load_dwordx4 v3, s[16:19], s47 offen lds
    s_mov_b32 m0, 41984
    s_add_u32 s47, s46, 442368
    buffer_load_dwordx4 v3, s[16:19], s47 offen lds
    s_mov_b32 m0, 43008
    s_add_u32 s47, s46, 516096
    buffer_load_dwordx4 v3, s[16:19], s47 offen lds
    s_mov_b32 m0, 44032
    s_add_u32 s47, s46, 525312
    buffer_load_dwordx4 v3, s[16:19], s47 offen lds
    s_waitcnt vmcnt(16)
    s_barrier
    s_mov_b32 m0, 45056
    s_add_u32 s47, s46, 599040
    buffer_load_dwordx4 v3, s[16:19], s47 offen lds
    s_mov_b32 m0, 46080
    s_add_u32 s47, s46, 608256
    buffer_load_dwordx4 v3, s[16:19], s47 offen lds
    s_mov_b32 m0, 47104
    s_add_u32 s47, s46, 681984
    buffer_load_dwordx4 v3, s[16:19], s47 offen lds
    s_mov_b32 m0, 48128
    s_add_u32 s47, s46, 691200
    buffer_load_dwordx4 v3, s[16:19], s47 offen lds
    s_mov_b32 m0, 49152
    s_add_u32 s47, s46, 764928
    buffer_load_dwordx4 v3, s[16:19], s47 offen lds
    s_mov_b32 m0, 50176
    s_add_u32 s47, s46, 774144
    buffer_load_dwordx4 v3, s[16:19], s47 offen lds
    s_mov_b32 m0, 51200
    s_add_u32 s47, s46, 847872
    buffer_load_dwordx4 v3, s[16:19], s47 offen lds
    s_mov_b32 m0, 52224
    s_add_u32 s47, s46, 857088
    buffer_load_dwordx4 v3, s[16:19], s47 offen lds
    s_mov_b32 m0, 53248
    s_add_u32 s47, s46, 930816
    buffer_load_dwordx4 v3, s[16:19], s47 offen lds
    s_mov_b32 m0, 54272
    s_add_u32 s47, s46, 940032
    buffer_load_dwordx4 v3, s[16:19], s47 offen lds
    s_mov_b32 m0, 55296
    s_add_u32 s47, s46, 1013760
    buffer_load_dwordx4 v3, s[16:19], s47 offen lds
    s_mov_b32 m0, 56320
    s_add_u32 s47, s46, 1022976
    buffer_load_dwordx4 v3, s[16:19], s47 offen lds
    s_waitcnt vmcnt(16)
    s_barrier
    s_mov_b32 m0, 57344
    s_add_u32 s47, s46, 1096704
    buffer_load_dwordx4 v3, s[16:19], s47 offen lds
    s_mov_b32 m0, 58368
    s_add_u32 s47, s46, 1105920
    buffer_load_dwordx4 v3, s[16:19], s47 offen lds
    s_mov_b32 m0, 59392
    s_add_u32 s47, s46, 1179648
    buffer_load_dwordx4 v3, s[16:19], s47 offen lds
    s_mov_b32 m0, 60416
    s_add_u32 s47, s46, 1188864
    buffer_load_dwordx4 v3, s[16:19], s47 offen lds
    s_mov_b32 m0, 61440
    s_add_u32 s47, s46, 73728
    buffer_load_dwordx4 v3, s[16:19], s47 offen lds
    s_mov_b32 m0, 62464
    s_add_u32 s47, s46, 156672
    buffer_load_dwordx4 v3, s[16:19], s47 offen lds
    s_mov_b32 m0, 63488
    s_add_u32 s47, s46, 239616
    buffer_load_dwordx4 v3, s[16:19], s47 offen lds
    s_mov_b32 m0, 64512
    s_add_u32 s47, s46, 322560
    buffer_load_dwordx4 v3, s[16:19], s47 offen lds
    s_mov_b32 m0, 0
    s_add_u32 s47, s46, 405504
    buffer_load_dwordx4 v3, s[16:19], s47 offen lds
    s_mov_b32 m0, 1024
    s_add_u32 s47, s46, 488448
    buffer_load_dwordx4 v3, s[16:19], s47 offen lds
    s_mov_b32 m0, 2048
    s_add_u32 s47, s46, 571392
    buffer_load_dwordx4 v3, s[16:19], s47 offen lds
    s_mov_b32 m0, 3072
    s_add_u32 s47, s46, 654336
    buffer_load_dwordx4 v3, s[16:19], s47 offen lds
    s_waitcnt vmcnt(16)
    s_barrier
    s_mov_b32 m0, 4096
    s_add_u32 s47, s46, 737280
    buffer_load_dwordx4 v3, s[16:19], s47 offen lds
    s_mov_b32 m0, 5120
    s_add_u32 s47, s46, 820224
    buffer_load_dwordx4 v3, s[16:19], s47 offen lds
    s_mov_b32 m0, 6144
    s_add_u32 s47, s46, 903168
    buffer_load_dwordx4 v3, s[16:19], s47 offen lds
    s_mov_b32 m0, 7168
    s_add_u32 s47, s46, 986112
    buffer_load_dwordx4 v3, s[16:19], s47 offen lds
    s_mov_b32 m0, 8192
    s_add_u32 s47, s46, 1069056
    buffer_load_dwordx4 v3, s[16:19], s47 offen lds
    s_mov_b32 m0, 9216
    s_add_u32 s47, s46, 1152000
    buffer_load_dwordx4 v3, s[16:19], s47 offen lds
    s_mov_b32 m0, 10240
    s_add_u32 s47, s46, 1234944
    buffer_load_dwordx4 v3, s[16:19], s47 offen lds
    s_mov_b32 m0, 11264
    s_add_u32 s47, s46, 1317888
    buffer_load_dwordx4 v3, s[16:19], s47 offen lds
    s_mov_b32 m0, 12288
    s_add_u32 s47, s46, 36864
    buffer_load_dwordx4 v3, s[16:19], s47 offen lds
    s_mov_b32 m0, 13312
    s_add_u32 s47, s46, 46080
    buffer_load_dwordx4 v3, s[16:19], s47 offen lds
    s_mov_b32 m0, 14336
    s_add_u32 s47, s46, 119808
    buffer_load_dwordx4 v3, s[16:19], s47 offen lds
    s_mov_b32 m0, 15360
    s_add_u32 s47, s46, 129024
    buffer_load_dwordx4 v3, s[16:19], s47 offen lds
    s_mov_b32 m0, 16384
    s_add_u32 s47, s46, 202752
    buffer_load_dwordx4 v3, s[16:19], s47 offen lds
    s_mov_b32 m0, 17408
    s_add_u32 s47, s46, 211968
    buffer_load_dwordx4 v3, s[16:19], s47 offen lds
    s_mov_b32 m0, 18432
    s_add_u32 s47, s46, 285696
    buffer_load_dwordx4 v3, s[16:19], s47 offen lds
    s_mov_b32 m0, 19456
    s_add_u32 s47, s46, 294912
    buffer_load_dwordx4 v3, s[16:19], s47 offen lds
    s_waitcnt vmcnt(20)
    s_barrier
    s_mov_b32 m0, 20480
    s_add_u32 s47, s46, 368640
    buffer_load_dwordx4 v3, s[16:19], s47 offen lds
    s_mov_b32 m0, 21504
    s_add_u32 s47, s46, 377856
    buffer_load_dwordx4 v3, s[16:19], s47 offen lds
    s_mov_b32 m0, 22528
    s_add_u32 s47, s46, 451584
    buffer_load_dwordx4 v3, s[16:19], s47 offen lds
    s_mov_b32 m0, 23552
    s_add_u32 s47, s46, 460800
    buffer_load_dwordx4 v3, s[16:19], s47 offen lds
    s_mov_b32 m0, 24576
    s_add_u32 s47, s46, 534528
    buffer_load_dwordx4 v3, s[16:19], s47 offen lds
    s_mov_b32 m0, 25600
    s_add_u32 s47, s46, 543744
    buffer_load_dwordx4 v3, s[16:19], s47 offen lds
    s_mov_b32 m0, 26624
    s_add_u32 s47, s46, 617472
    buffer_load_dwordx4 v3, s[16:19], s47 offen lds
    s_mov_b32 m0, 27648
    s_add_u32 s47, s46, 626688
    buffer_load_dwordx4 v3, s[16:19], s47 offen lds
    s_mov_b32 m0, 28672
    s_add_u32 s47, s46, 700416
    buffer_load_dwordx4 v3, s[16:19], s47 offen lds
    s_mov_b32 m0, 29696
    s_add_u32 s47, s46, 709632
    buffer_load_dwordx4 v3, s[16:19], s47 offen lds
    s_mov_b32 m0, 30720
    s_add_u32 s47, s46, 783360
    buffer_load_dwordx4 v3, s[16:19], s47 offen lds
    s_mov_b32 m0, 31744
    s_add_u32 s47, s46, 792576
    buffer_load_dwordx4 v3, s[16:19], s47 offen lds
    s_mov_b32 m0, 32768
    s_add_u32 s47, s46, 866304
    buffer_load_dwordx4 v3, s[16:19], s47 offen lds
    s_mov_b32 m0, 33792
    s_add_u32 s47, s46, 875520
    buffer_load_dwordx4 v3, s[16:19], s47 offen lds
    s_mov_b32 m0, 34816
    s_add_u32 s47, s46, 949248
    buffer_load_dwordx4 v3, s[16:19], s47 offen lds
    s_mov_b32 m0, 35840
    s_add_u32 s47, s46, 958464
    buffer_load_dwordx4 v3, s[16:19], s47 offen lds
    s_waitcnt vmcnt(24)
    s_barrier
    s_mov_b32 m0, 36864
    s_add_u32 s47, s46, 1032192
    buffer_load_dwordx4 v3, s[16:19], s47 offen lds
    s_mov_b32 m0, 37888
    s_add_u32 s47, s46, 1041408
    buffer_load_dwordx4 v3, s[16:19], s47 offen lds
    s_mov_b32 m0, 38912
    s_add_u32 s47, s46, 1115136
    buffer_load_dwordx4 v3, s[16:19], s47 offen lds
    s_mov_b32 m0, 39936
    s_add_u32 s47, s46, 1124352
    buffer_load_dwordx4 v3, s[16:19], s47 offen lds
    s_mov_b32 m0, 40960
    s_add_u32 s47, s46, 1198080
    buffer_load_dwordx4 v3, s[16:19], s47 offen lds
    s_mov_b32 m0, 41984
    s_add_u32 s47, s46, 1207296
    buffer_load_dwordx4 v3, s[16:19], s47 offen lds
    s_mov_b32 m0, 43008
    s_add_u32 s47, s46, 55296
    buffer_load_dwordx4 v3, s[16:19], s47 offen lds
    s_mov_b32 m0, 44032
    s_add_u32 s47, s46, 64512
    buffer_load_dwordx4 v3, s[16:19], s47 offen lds
    s_mov_b32 m0, 45056
    s_add_u32 s47, s46, 138240
    buffer_load_dwordx4 v3, s[16:19], s47 offen lds
    s_mov_b32 m0, 46080
    s_add_u32 s47, s46, 147456
    buffer_load_dwordx4 v3, s[16:19], s47 offen lds
    s_mov_b32 m0, 47104
    s_add_u32 s47, s46, 221184
    buffer_load_dwordx4 v3, s[16:19], s47 offen lds
    s_mov_b32 m0, 48128
    s_add_u32 s47, s46, 230400
    buffer_load_dwordx4 v3, s[16:19], s47 offen lds
    s_mov_b32 m0, 49152
    s_add_u32 s47, s46, 304128
    buffer_load_dwordx4 v3, s[16:19], s47 offen lds
    s_mov_b32 m0, 50176
    s_add_u32 s47, s46, 313344
    buffer_load_dwordx4 v3, s[16:19], s47 offen lds
    s_waitcnt vmcnt(26)
    s_barrier
    s_mov_b32 m0, 51200
    s_add_u32 s47, s46, 387072
    buffer_load_dwordx4 v3, s[16:19], s47 offen lds
    s_mov_b32 m0, 52224
    s_add_u32 s47, s46, 396288
    buffer_load_dwordx4 v3, s[16:19], s47 offen lds
    s_mov_b32 m0, 53248
    s_add_u32 s47, s46, 470016
    buffer_load_dwordx4 v3, s[16:19], s47 offen lds
    s_mov_b32 m0, 54272
    s_add_u32 s47, s46, 479232
    buffer_load_dwordx4 v3, s[16:19], s47 offen lds
    s_mov_b32 m0, 55296
    s_add_u32 s47, s46, 552960
    buffer_load_dwordx4 v3, s[16:19], s47 offen lds
    s_mov_b32 m0, 56320
    s_add_u32 s47, s46, 562176
    buffer_load_dwordx4 v3, s[16:19], s47 offen lds
    s_mov_b32 m0, 57344
    s_add_u32 s47, s46, 635904
    buffer_load_dwordx4 v3, s[16:19], s47 offen lds
    s_mov_b32 m0, 58368
    s_add_u32 s47, s46, 645120
    buffer_load_dwordx4 v3, s[16:19], s47 offen lds
    s_mov_b32 m0, 59392
    s_add_u32 s47, s46, 718848
    buffer_load_dwordx4 v3, s[16:19], s47 offen lds
    s_mov_b32 m0, 60416
    s_add_u32 s47, s46, 728064
    buffer_load_dwordx4 v3, s[16:19], s47 offen lds
    s_mov_b32 m0, 61440
    s_add_u32 s47, s46, 801792
    buffer_load_dwordx4 v3, s[16:19], s47 offen lds
    s_mov_b32 m0, 62464
    s_add_u32 s47, s46, 811008
    buffer_load_dwordx4 v3, s[16:19], s47 offen lds
    s_mov_b32 m0, 63488
    s_add_u32 s47, s46, 884736
    buffer_load_dwordx4 v3, s[16:19], s47 offen lds
    s_mov_b32 m0, 64512
    s_add_u32 s47, s46, 893952
    buffer_load_dwordx4 v3, s[16:19], s47 offen lds
    s_waitcnt vmcnt(24)
    s_barrier
    s_mov_b32 m0, 0
    s_add_u32 s47, s46, 967680
    buffer_load_dwordx4 v3, s[16:19], s47 offen lds
    s_mov_b32 m0, 1024
    s_add_u32 s47, s46, 976896
    buffer_load_dwordx4 v3, s[16:19], s47 offen lds
    s_mov_b32 m0, 2048
    s_add_u32 s47, s46, 1050624
    buffer_load_dwordx4 v3, s[16:19], s47 offen lds
    s_mov_b32 m0, 3072
    s_add_u32 s47, s46, 1059840
    buffer_load_dwordx4 v3, s[16:19], s47 offen lds
    s_mov_b32 m0, 4096
    s_add_u32 s47, s46, 1133568
    buffer_load_dwordx4 v3, s[16:19], s47 offen lds
    s_mov_b32 m0, 5120
    s_add_u32 s47, s46, 1142784
    buffer_load_dwordx4 v3, s[16:19], s47 offen lds
    s_mov_b32 m0, 6144
    s_add_u32 s47, s46, 1216512
    buffer_load_dwordx4 v3, s[16:19], s47 offen lds
    s_mov_b32 m0, 7168
    s_add_u32 s47, s46, 1225728
    buffer_load_dwordx4 v3, s[16:19], s47 offen lds
    s_waitcnt vmcnt(8)
    s_barrier
    s_waitcnt vmcnt(0)
    s_barrier
    s_barrier
    s_mov_b32 s32, s8
    s_and_b32 s33, s9, 0xffff
    s_mov_b32 s34, 41472
    s_mov_b32 s35, 0x20000
    v_lshlrev_b32 v3, 4, v2
    s_mov_b32 m0, 21504
    s_mov_b32 s47, 21504
    buffer_load_dwordx4 v3, s[32:35], s47 offen offset:0 lds
    buffer_load_dwordx4 v3, s[32:35], s47 offen offset:1024 lds
    buffer_load_dwordx4 v3, s[32:35], s47 offen offset:2048 lds
    buffer_load_dwordx4 v3, s[32:35], s47 offen offset:3072 lds
    s_mov_b32 m0, 25600
    s_mov_b32 s47, 25600
    buffer_load_dwordx4 v3, s[32:35], s47 offen offset:0 lds
    buffer_load_dwordx4 v3, s[32:35], s47 offen offset:1024 lds
    buffer_load_dwordx4 v3, s[32:35], s47 offen offset:2048 lds
    buffer_load_dwordx4 v3, s[32:35], s47 offen offset:3072 lds
    s_mov_b32 m0, 29696
    s_mov_b32 s47, 29696
    buffer_load_dwordx4 v3, s[32:35], s47 offen offset:0 lds
    buffer_load_dwordx4 v3, s[32:35], s47 offen offset:1024 lds
    buffer_load_dwordx4 v3, s[32:35], s47 offen offset:2048 lds
    buffer_load_dwordx4 v3, s[32:35], s47 offen offset:3072 lds
    s_mov_b32 m0, 33792
    s_mov_b32 s47, 33792
    buffer_load_dwordx4 v3, s[32:35], s47 offen offset:0 lds
    buffer_load_dwordx4 v3, s[32:35], s47 offen offset:1024 lds
    buffer_load_dwordx4 v3, s[32:35], s47 offen offset:2048 lds
    buffer_load_dwordx4 v3, s[32:35], s47 offen offset:3072 lds
    s_mov_b32 m0, 37888
    s_mov_b32 s47, 37888
    buffer_load_dwordx4 v3, s[32:35], s47 offen offset:0 lds
    buffer_load_dwordx4 v3, s[32:35], s47 offen offset:1024 lds
    buffer_load_dwordx4 v3, s[32:35], s47 offen offset:2048 lds
    buffer_load_dwordx4 v3, s[32:35], s47 offen offset:3072 lds
    s_waitcnt vmcnt(0)
    s_endpgm
L_end:
    s_endpgm
.fill 32, 4, 0xbf800000
L_textend:

.section .rodata,"a"
.p2align 6
.amdhsa_kernel standalone__autoregressive_conv_wavenet__speech_kernel
  .amdhsa_next_free_vgpr 240
  .amdhsa_next_free_sgpr 100
  .amdhsa_accum_offset 240
  .amdhsa_group_segment_fixed_size 0
  .amdhsa_kernarg_size 48
  .amdhsa_user_sgpr_count 2
  .amdhsa_user_sgpr_kernarg_segment_ptr 1
  .amdhsa_system_sgpr_workgroup_id_x 1
.end_amdhsa_kernel
```
